```python
import torch

def _softmax(x, axis=-1):
    return torch.softmax(x, dim=axis)
def _gelu(x):
    return torch.nn.functional.gelu(x, approximate="tanh")
def _silu(x):
    return torch.nn.functional.silu(x)
def _sigmoid(x):
    return torch.sigmoid(x)
def _layernorm(x, axis=-1, eps=1e-5):
    m = x.mean(dim=axis, keepdim=True)
    v = x.var(dim=axis, keepdim=True, unbiased=False)
    return (x - m) / torch.sqrt(v + eps)
def _scatter_add(tgt, idx, src, axis=0):
    return tgt.clone().index_add_(axis, idx, src)
def _segment_sum(src, seg, n):
    out = torch.zeros((n,) + src.shape[1:], dtype=src.dtype)
    return out.index_add_(0, seg, src)
def _pad(x, pw):
    flat = tuple(v for pair in reversed(pw) for v in pair)
    return torch.nn.functional.pad(x, flat)

kernel_name = 'recurrent_scan__gqa_block_cached__glu_gated_geglu__decode'

def setup_inputs():

    _w = (lambda a: (lambda t: t.to(torch.bfloat16) if t.is_floating_point() else t)(torch.as_tensor(a)))
    def _A_setup():
        B, Sq, D = 1, 1, 512
        Hq, Hkv, Sk, Dh = 32, 8, 32768, 128
        assert Hq % Hkv == 0, (Hq, Hkv)
        return {
            "x": _w((lambda *s: torch.randn(*s, dtype=torch.bfloat16) * 0.4)(B, Sq, D)),
            "k_cache": _w((lambda *s: torch.randn(*s, dtype=torch.bfloat16) * 1.6)(B, Hkv, Sk, Dh)),
            "v_cache": _w((lambda *s: torch.randn(*s, dtype=torch.bfloat16) * 1.6)(B, Hkv, Sk, Dh)),
            "wq": _w((lambda *s: torch.randn(*s, dtype=torch.bfloat16) * 1.6)(D, Hq * Dh) * (D ** -0.5)),
            "wo": _w((lambda *s: torch.randn(*s, dtype=torch.bfloat16) * 1.6)(Hq * Dh, D) * ((Hq * Dh) ** -0.5)),
        }
    _A_in = _A_setup()

    def _B_setup():
        B, S, Dm, Df = 1, 1, 512, 1792
        return {
            "x": _w((lambda *s: torch.randn(*s, dtype=torch.bfloat16) * 0.4)(B, S, Dm)),
            "w_gate": _w((lambda *s: torch.randn(*s, dtype=torch.bfloat16) * 1.6)(Dm, Df) * (Dm ** -0.5)),
            "w_up": _w((lambda *s: torch.randn(*s, dtype=torch.bfloat16) * 1.6)(Dm, Df) * (Dm ** -0.5)),
            "w_down": _w((lambda *s: torch.randn(*s, dtype=torch.bfloat16) * 1.6)(Df, Dm) * (Df ** -0.5)),
        }
    _B_in = _B_setup()

    return {
        "A_x": _A_in["x"],
        "A_k_cache": _A_in["k_cache"],
        "A_v_cache": _A_in["v_cache"],
        "A_wq": _A_in["wq"],
        "A_wo": _A_in["wo"],
        "B_x": _B_in["x"],
        "B_w_gate": _B_in["w_gate"],
        "B_w_up": _B_in["w_up"],
        "B_w_down": _B_in["w_down"],
    }

def reference(A_x, A_k_cache, A_v_cache, A_wq, A_wo, B_x, B_w_gate, B_w_up, B_w_down):
    def _A_ref(x, k_cache, v_cache, wq, wo):
        B, Sq, D = x.shape
        Hq, Dh = 32, 128
        Hkv = k_cache.shape[1]
        rep = Hq // Hkv
        q = (lambda x, *d: x.permute(*d))((x @ wq).reshape(B, Sq, Hq, Dh), 0, 2, 1, 3)
        k = (lambda x, n, axis: torch.repeat_interleave(x, n, dim=axis))(k_cache, rep, axis=1)
        v = (lambda x, n, axis: torch.repeat_interleave(x, n, dim=axis))(v_cache, rep, axis=1)
        scores = torch.einsum("bhqd,bhkd->bhqk", q, k) * (Dh ** -0.5)
        p = _softmax(scores, axis=-1)
        o = torch.einsum("bhqk,bhkd->bhqd", p, v)
        return (lambda x, *d: x.permute(*d))(o, 0, 2, 1, 3).reshape(B, Sq, Hq * Dh) @ wo

    def _B_ref(x, w_gate, w_up, w_down):
        g = torch.einsum("bsd,df->bsf", x, w_gate)
        u = torch.einsum("bsd,df->bsf", x, w_up)
        h = _gelu(g) * u
        return torch.einsum("bsf,fd->bsd", h, w_down)

    x = A_x
    xn = _layernorm(x, axis=-1)
    s = _A_ref(xn, A_k_cache, A_v_cache, A_wq, A_wo)
    g = _silu(_B_ref(xn, B_w_gate, B_w_up, B_w_down))
    return x + s * g
```

```asm
; @launch grid=(256,1,1) block=(512,1,1) lds=30976
.amdgcn_target "amdgcn-amd-amdhsa--gfx950"
.text
.globl recurrent_scan__gqa_block_cached__glu_gated_geglu__decode_kernel
.p2align 8
.type recurrent_scan__gqa_block_cached__glu_gated_geglu__decode_kernel,@function
recurrent_scan__gqa_block_cached__glu_gated_geglu__decode_kernel:
    s_cmp_ge_u32 s2, 256
    s_cbranch_scc1 L_end
    s_load_dwordx16 s[4:19], s[0:1], 0
    s_load_dwordx8 s[20:27], s[0:1], 64
    v_mov_b32 v5, 0
    v_mov_b32 v36, 0
    v_mov_b32 v37, 0
    v_mov_b32 v38, 0
    v_mov_b32 v39, 0
    v_and_b32 v1, 63, v0
    v_lshrrev_b32 v14, 6, v0
    ds_write_b128 v5, v[36:39] offset:0
    v_lshlrev_b32 v3, 4, v1
    v_readfirstlane_b32 s3, v14
    v_lshrrev_b32 v53, 3, v1
    v_and_b32 v54, 7, v1
    v_lshlrev_b32 v46, 17, v53
    v_lshl_add_u32 v46, v54, 4, v46
    v_mul_u32_u24 v47, 57344, v53
    v_lshl_add_u32 v47, v54, 4, v47
    s_and_b32 s36, s2, 7
    s_lshr_b32 s37, s2, 3
    s_lshr_b32 s40, s37, 3
    s_lshl_b32 s40, s40, 20
    s_lshl_b32 s41, s3, 14
    s_add_u32 s40, s40, s41
    s_and_b32 s41, s37, 7
    s_lshl_b32 s41, s41, 7
    s_add_u32 s40, s40, s41
    s_lshl_b32 s41, s36, 10
    s_add_u32 s40, s40, s41
    s_sub_u32 s42, s37, 4
    s_cmp_lt_u32 s2, 224
    s_cselect_b32 s42, s37, s42
    s_lshl_b32 s42, s42, 7
    s_and_b32 s41, s2, 3
    s_lshl_b32 s41, s41, 6
    s_add_u32 s41, s41, s3
    s_mul_i32 s41, s41, 7168
    s_add_u32 s41, s41, s42
    s_add_u32 s42, s40, 0x2000
    v_bfe_u32 v15, v1, 2, 2
    v_lshlrev_b32 v2, 8, v15
    v_lshrrev_b32 v15, 4, v1
    v_lshl_add_u32 v2, v15, 6, v2
    v_and_b32 v15, 3, v1
    v_lshl_add_u32 v2, v15, 4, v2
    s_lshl_b32 s38, s36, 23
    s_lshl_b32 s43, s37, 18
    s_add_u32 s38, s38, s43
    s_lshl_b32 s43, s3, 12
    s_add_u32 s38, s38, s43
    s_mov_b32 s39, s38
    s_mov_b32 s30, 0x4000000
    s_mov_b32 s31, 0x20000
    s_mov_b32 s34, 0x4000000
    s_mov_b32 s35, 0x20000
    s_mov_b32 s54, 0x400000
    s_mov_b32 s55, 0x20000
    s_mov_b32 s58, 1835008
    s_mov_b32 s59, 0x20000
    s_bitcmp1_b32 s2, 2
    s_waitcnt lgkmcnt(0)
    s_cselect_b32 s56, s18, s16
    s_cselect_b32 s57, s19, s17
    s_mov_b32 s28, s6
    s_mov_b32 s29, s7
    global_load_dwordx4 v[72:75], v3, s[4:5]
    s_mov_b32 s52, s10
    s_mov_b32 s53, s11
    buffer_load_dwordx4 v[56:59], v46, s[52:55], s40 offen nt
    buffer_load_dwordx4 v[60:63], v46, s[52:55], s42 offen nt
    buffer_load_dwordx4 v[64:67], v47, s[56:59], s41 offen nt
    buffer_load_dwordx4 v[68:71], v47, s[56:59], s41 offen offset:3584 nt
    s_mov_b32 s32, s8
    s_mov_b32 s33, s9
    buffer_load_dwordx4 v[128:131], v2, s[28:31], s38 offen offset:0 nt
    buffer_load_dwordx4 v[132:135], v2, s[28:31], s38 offen offset:1024 nt
    s_mov_b64 s[16:17], 0
    s_mov_b64 s[18:19], 0
    s_load_dword s14, s[26:27], 0x40000
    s_barrier
    s_mov_b32 s44, 0xffff0000
    s_mov_b32 s49, 0xffffff00
    s_movk_i32 s100, 0xff
    s_lshr_b32 s50, s37, 2
    s_and_b32 s51, s37, 3
    s_lshl_b32 s47, s36, 3
    s_add_u32 s47, s47, s50
    v_mov_b32 v40, 0
    v_mov_b32 v41, 0
    v_mov_b32 v42, 0
    v_mov_b32 v43, 0
    v_mov_b32 v44, 0
    v_mov_b32 v45, 0
    v_and_b32 v104, 1, v54
    v_cmp_eq_u32 vcc, 1, v104
    v_mov_b32 v105, 0x0c0c0100
    v_mov_b32 v106, 0x01000c0c
    v_cndmask_b32 v105, v105, v106, vcc
    v_mov_b32 v107, 0x0c0c0302
    v_mov_b32 v106, 0x03020c0c
    v_cndmask_b32 v106, v107, v106, vcc
    v_mov_b32 v107, 0x0c0c0c0c
    v_lshrrev_b32 v104, 1, v54
    v_cmp_eq_u32 vcc, 0, v104
    s_nop 1
    v_cndmask_b32 v88, v107, v105, vcc
    v_cndmask_b32 v89, v107, v106, vcc
    v_cmp_eq_u32 vcc, 1, v104
    s_nop 1
    v_cndmask_b32 v90, v107, v105, vcc
    v_cndmask_b32 v91, v107, v106, vcc
    v_cmp_eq_u32 vcc, 2, v104
    s_nop 1
    v_cndmask_b32 v92, v107, v105, vcc
    v_cndmask_b32 v93, v107, v106, vcc
    v_cmp_eq_u32 vcc, 3, v104
    s_nop 1
    v_cndmask_b32 v94, v107, v105, vcc
    v_cndmask_b32 v95, v107, v106, vcc
    s_lshr_b32 s40, s37, 3
    s_lshl_b32 s40, s40, 8
    s_lshl_b32 s41, s3, 2
    s_add_u32 s42, s40, s41
    v_lshlrev_b32 v49, 5, v53
    v_xor_b32 v50, 32, v49
    v_add_u32 v49, s42, v49
    s_and_b32 s42, s2, 3
    s_lshl_b32 s42, s42, 8
    s_add_u32 s42, s42, s41
    v_add_u32 v50, s42, v50
    s_lshl_b32 s42, s36, 13
    s_and_b32 s41, s37, 7
    s_lshl_b32 s41, s41, 10
    s_add_u32 s40, s40, s41
    s_add_u32 s40, s40, s42
    s_lshl_b32 s41, s2, 8
    s_add_u32 s41, s41, 0x10000
    v_mov_b32 v104, s40
    v_mov_b32 v105, s41
    v_and_b32 v106, 1, v53
    v_cmp_eq_u32 vcc, 1, v106
    s_nop 1
    v_cndmask_b32 v48, v104, v105, vcc
    v_bfe_u32 v106, v1, 4, 1
    v_lshl_add_u32 v106, v54, 1, v106
    v_lshl_add_u32 v48, v106, 4, v48
    s_lshl_b32 s41, s3, 10
    s_add_u32 s42, s42, s41
    v_add_u32 v51, s42, v3
    v_and_b32 v104, 15, v1
    v_lshrrev_b32 v105, 4, v1
    v_lshl_add_u32 v104, v104, 2, v105
    s_lshl_b32 s42, s3, 6
    v_add_lshl_u32 v52, v104, s42, 1
    v_add_u32 v55, s41, v3
    s_waitcnt vmcnt(6)
    v_lshlrev_b32 v76, 16, v72
    v_and_b32 v77, s44, v72
    v_lshlrev_b32 v78, 16, v73
    v_and_b32 v79, s44, v73
    v_lshlrev_b32 v80, 16, v74
    v_and_b32 v81, s44, v74
    v_lshlrev_b32 v82, 16, v75
    v_and_b32 v83, s44, v75
    v_add_f32 v84, v76, v77
    v_add_f32 v85, v78, v79
    v_add_f32 v86, v80, v81
    v_add_f32 v87, v82, v83
    v_add_f32 v84, v84, v85
    v_add_f32 v86, v86, v87
    v_add_f32 v84, v84, v86
    s_nop 1
    v_add_f32_dpp v84, v84, v84 row_ror:8 row_mask:0xf bank_mask:0xf
    s_nop 1
    v_add_f32_dpp v84, v84, v84 row_ror:4 row_mask:0xf bank_mask:0xf
    s_nop 1
    v_add_f32_dpp v84, v84, v84 row_ror:2 row_mask:0xf bank_mask:0xf
    s_nop 1
    v_add_f32_dpp v84, v84, v84 row_ror:1 row_mask:0xf bank_mask:0xf
    v_mov_b32 v85, v84
    s_nop 1
    v_permlane16_swap_b32 v85, v84
    v_add_f32 v84, v85, v84
    v_mov_b32 v85, v84
    s_nop 1
    v_permlane32_swap_b32 v85, v84
    v_add_f32 v84, v85, v84
    v_mul_f32 v84, 0x3b000000, v84
    v_sub_f32 v104, v76, v84
    v_sub_f32 v105, v77, v84
    v_sub_f32 v106, v78, v84
    v_sub_f32 v107, v79, v84
    v_sub_f32 v108, v80, v84
    v_sub_f32 v109, v81, v84
    v_sub_f32 v110, v82, v84
    v_sub_f32 v111, v83, v84
    v_mul_f32 v86, v104, v104
    v_mul_f32 v87, v105, v105
    v_fmac_f32 v86, v106, v106
    v_fmac_f32 v87, v107, v107
    v_fmac_f32 v86, v108, v108
    v_fmac_f32 v87, v109, v109
    v_fmac_f32 v86, v110, v110
    v_fmac_f32 v87, v111, v111
    v_add_f32 v86, v86, v87
    v_cvt_pk_bf16_f32 v85, v84, v84
    v_lshlrev_b32 v84, 16, v85
    v_add_f32_dpp v86, v86, v86 row_ror:8 row_mask:0xf bank_mask:0xf
    v_sub_f32 v104, v76, v84
    v_sub_f32 v105, v77, v84
    v_add_f32_dpp v86, v86, v86 row_ror:4 row_mask:0xf bank_mask:0xf
    v_sub_f32 v106, v78, v84
    v_sub_f32 v107, v79, v84
    v_add_f32_dpp v86, v86, v86 row_ror:2 row_mask:0xf bank_mask:0xf
    v_sub_f32 v108, v80, v84
    v_sub_f32 v109, v81, v84
    v_add_f32_dpp v86, v86, v86 row_ror:1 row_mask:0xf bank_mask:0xf
    v_sub_f32 v110, v82, v84
    v_sub_f32 v111, v83, v84
    v_mov_b32 v85, v86
    s_nop 1
    v_permlane16_swap_b32 v85, v86
    v_add_f32 v86, v85, v86
    v_mov_b32 v85, v86
    s_nop 1
    v_permlane32_swap_b32 v85, v86
    v_add_f32 v86, v85, v86
    v_mul_f32 v86, 0x3b000000, v86
    v_cvt_pk_bf16_f32 v96, v104, v105
    v_cvt_pk_bf16_f32 v97, v106, v107
    v_cvt_pk_bf16_f32 v98, v108, v109
    v_cvt_pk_bf16_f32 v99, v110, v111
    v_cvt_pk_bf16_f32 v85, v86, v86
    v_lshlrev_b32 v86, 16, v85
    v_add_f32 v86, 0x3727c5ac, v86
    v_cvt_pk_bf16_f32 v85, v86, v86
    v_lshlrev_b32 v86, 16, v85
    v_sqrt_f32 v86, v86
    v_lshlrev_b32 v104, 16, v96
    v_and_b32 v105, s44, v96
    v_lshlrev_b32 v106, 16, v97
    v_and_b32 v107, s44, v97
    v_lshlrev_b32 v108, 16, v98
    v_and_b32 v109, s44, v98
    v_lshlrev_b32 v110, 16, v99
    v_and_b32 v111, s44, v99
    v_cvt_pk_bf16_f32 v85, v86, v86
    v_lshlrev_b32 v86, 16, v85
    v_rcp_f32 v87, v86
    s_nop 0
    v_mul_f32 v76, v104, v87
    v_mul_f32 v77, v105, v87
    v_mul_f32 v78, v106, v87
    v_mul_f32 v79, v107, v87
    v_mul_f32 v80, v108, v87
    v_mul_f32 v81, v109, v87
    v_mul_f32 v82, v110, v87
    v_mul_f32 v83, v111, v87
    v_fma_f32 v104, -v76, v86, v104
    v_fma_f32 v105, -v77, v86, v105
    v_fma_f32 v106, -v78, v86, v106
    v_fma_f32 v107, -v79, v86, v107
    v_fma_f32 v108, -v80, v86, v108
    v_fma_f32 v109, -v81, v86, v109
    v_fma_f32 v110, -v82, v86, v110
    v_fma_f32 v111, -v83, v86, v111
    v_fma_f32 v104, v104, v87, v76
    v_fma_f32 v105, v105, v87, v77
    v_fma_f32 v106, v106, v87, v78
    v_fma_f32 v107, v107, v87, v79
    v_fma_f32 v108, v108, v87, v80
    v_fma_f32 v109, v109, v87, v81
    v_fma_f32 v110, v110, v87, v82
    v_fma_f32 v111, v111, v87, v83
    v_cvt_pk_bf16_f32 v96, v104, v105
    v_cvt_pk_bf16_f32 v97, v106, v107
    v_cvt_pk_bf16_f32 v98, v108, v109
    v_cvt_pk_bf16_f32 v99, v110, v111
    ds_write_b128 v3, v[96:99] offset:10240
    ds_read_b32 v100, v49 offset:10240
    ds_read_b32 v101, v50 offset:10240
    s_mov_b32 vcc_lo, 0x00ff00ff
    s_mov_b32 vcc_hi, 0xff00ff00
    v_mov_b32 v84, 1
    s_waitcnt lgkmcnt(0)
    s_add_u32 s14, s14, 1
    s_and_b32 s15, s14, 0xff
    v_mov_b32 v0, s15
    v_perm_b32 v104, v100, v100, v88
    v_perm_b32 v105, v100, v100, v90
    v_perm_b32 v106, v100, v100, v92
    v_perm_b32 v107, v100, v100, v94
    v_perm_b32 v108, v100, v100, v89
    v_perm_b32 v109, v100, v100, v91
    v_perm_b32 v110, v100, v100, v93
    v_perm_b32 v111, v100, v100, v95
    v_perm_b32 v112, v101, v101, v88
    v_perm_b32 v113, v101, v101, v90
    v_perm_b32 v114, v101, v101, v92
    v_perm_b32 v115, v101, v101, v94
    v_perm_b32 v116, v101, v101, v89
    v_perm_b32 v117, v101, v101, v91
    v_perm_b32 v118, v101, v101, v93
    v_perm_b32 v119, v101, v101, v95
    s_waitcnt vmcnt(5)
    v_mfma_f32_16x16x32_bf16 v[120:123], v[104:107], v[56:59], 0
    s_waitcnt vmcnt(3)
    v_mfma_f32_16x16x32_bf16 v[124:127], v[112:115], v[64:67], 0
    v_mfma_f32_16x16x32_bf16 v[120:123], v[108:111], v[60:63], v[120:123]
    s_waitcnt vmcnt(2)
    v_mfma_f32_16x16x32_bf16 v[124:127], v[116:119], v[68:71], v[124:127]
L_t2:
    buffer_load_dwordx4 v[136:139], v2, s[28:31], s38 offen offset:2048 nt
    s_nop 6
    v_cndmask_b32 v120, v124, v120, vcc
    v_cndmask_b32 v121, v125, v121, vcc
    v_cndmask_b32 v122, v126, v122, vcc
    v_cndmask_b32 v123, v127, v123, vcc
    ds_write_b128 v55, v[120:123] offset:2048
    s_mov_b64 exec, 1
    ds_add_rtn_u32 v84, v5, v84 offset:12
    s_mov_b64 exec, -1
    s_bitcmp1_b64 s[16:17], 3
    s_cbranch_scc1 L_t3
    s_waitcnt vmcnt(2)
L_t3:
    buffer_load_dwordx4 v[140:143], v2, s[28:31], s38 offen offset:3072 nt
    s_waitcnt vmcnt(3)
    s_bitcmp1_b64 s[16:17], 4
    s_cbranch_scc1 L_t4
    s_waitcnt vmcnt(2)
L_t4:
    s_add_u32 s38, s38, 32768
    buffer_load_dwordx4 v[144:147], v2, s[28:31], s38 offen offset:0 nt
    s_waitcnt lgkmcnt(0)
    v_readfirstlane_b32 s40, v84
    s_lshl_b32 s41, s40, 2
    s_lshr_b32 s41, 0xc8550000, s41
    s_and_b32 s41, s41, 15
    s_lshl_b32 s42, s37, 2
    s_lshr_b32 s42, 0x20007000, s42
    s_and_b32 s42, s42, 15
    s_add_u32 s41, s41, s42
    s_bfm_b64 s[16:17], s41, 5
    s_cmp_eq_u32 s40, 7
    s_cbranch_scc0 L_nog
    ds_read_b128 v[56:59], v3 offset:2048
    ds_read_b128 v[60:63], v3 offset:3072
    ds_read_b128 v[64:67], v3 offset:4096
    ds_read_b128 v[68:71], v3 offset:5120
    ds_read_b128 v[72:75], v3 offset:6144
    ds_read_b128 v[76:79], v3 offset:7168
    ds_read_b128 v[80:83], v3 offset:8192
    ds_read_b128 v[84:87], v3 offset:9216
    s_cmp_lt_u32 s2, 224
    s_cselect_b32 s40, -1, 0x00ff00ff
    s_mov_b32 s41, 0
    s_waitcnt lgkmcnt(6)
    v_add_f32 v56, v56, v60
    v_add_f32 v57, v57, v61
    v_add_f32 v58, v58, v62
    v_add_f32 v59, v59, v63
    s_waitcnt lgkmcnt(5)
    v_add_f32 v56, v56, v64
    v_add_f32 v57, v57, v65
    v_add_f32 v58, v58, v66
    v_add_f32 v59, v59, v67
    s_waitcnt lgkmcnt(4)
    v_add_f32 v56, v56, v68
    v_add_f32 v57, v57, v69
    v_add_f32 v58, v58, v70
    v_add_f32 v59, v59, v71
    s_waitcnt lgkmcnt(3)
    v_add_f32 v56, v56, v72
    v_add_f32 v57, v57, v73
    v_add_f32 v58, v58, v74
    v_add_f32 v59, v59, v75
    s_waitcnt lgkmcnt(2)
    v_add_f32 v56, v56, v76
    v_add_f32 v57, v57, v77
    v_add_f32 v58, v58, v78
    v_add_f32 v59, v59, v79
    s_waitcnt lgkmcnt(1)
    v_add_f32 v56, v56, v80
    v_add_f32 v57, v57, v81
    v_add_f32 v58, v58, v82
    v_add_f32 v59, v59, v83
    s_waitcnt lgkmcnt(0)
    v_add_f32 v56, v56, v84
    v_add_f32 v57, v57, v85
    v_add_f32 v58, v58, v86
    v_add_f32 v59, v59, v87
    v_permlane32_swap_b32 v56, v60
    v_permlane32_swap_b32 v57, v61
    v_permlane32_swap_b32 v58, v62
    v_permlane32_swap_b32 v59, v63
    v_add_f32_dpp v56, v60, v56 row_ror:8 row_mask:0xf bank_mask:0xf
    v_add_f32_dpp v57, v61, v57 row_ror:8 row_mask:0xf bank_mask:0xf
    v_add_f32_dpp v58, v62, v58 row_ror:8 row_mask:0xf bank_mask:0xf
    v_add_f32_dpp v59, v63, v59 row_ror:8 row_mask:0xf bank_mask:0xf
    v_and_or_b32 v56, v56, s49, v0
    v_and_or_b32 v57, v57, s49, v0
    v_and_or_b32 v58, v58, s49, v0
    v_and_or_b32 v59, v59, s49, v0
    s_mov_b64 exec, s[40:41]
    global_store_dwordx4 v48, v[56:59], s[26:27] sc1
    s_mov_b64 exec, -1
L_nog:
    s_nop 1
    s_waitcnt vmcnt(3)
    s_bitcmp1_b64 s[16:17], 5
    s_cbranch_scc1 L_t5
    s_waitcnt vmcnt(2)
L_t5:
    buffer_load_dwordx4 v[148:151], v2, s[28:31], s38 offen offset:1024 nt
    s_waitcnt vmcnt(3)
    s_bitcmp1_b64 s[16:17], 6
    s_cbranch_scc1 L_t6
    s_waitcnt vmcnt(2)
L_t6:
    buffer_load_dwordx4 v[152:155], v2, s[28:31], s38 offen offset:2048 nt
    s_waitcnt vmcnt(3)
    s_bitcmp1_b64 s[16:17], 7
    s_cbranch_scc1 L_t7
    s_waitcnt vmcnt(2)
L_t7:
    buffer_load_dwordx4 v[156:159], v2, s[28:31], s38 offen offset:3072 nt
    s_waitcnt vmcnt(3)
    s_bitcmp1_b64 s[16:17], 8
    s_cbranch_scc1 L_t8
    s_waitcnt vmcnt(2)
L_t8:
    s_add_u32 s38, s38, 32768
    buffer_load_dwordx4 v[160:163], v2, s[28:31], s38 offen offset:0 nt
    s_waitcnt vmcnt(3)
    s_bitcmp1_b64 s[16:17], 9
    s_cbranch_scc1 L_t9
    s_waitcnt vmcnt(2)
L_t9:
    buffer_load_dwordx4 v[164:167], v2, s[28:31], s38 offen offset:1024 nt
    s_waitcnt vmcnt(3)
    s_bitcmp1_b64 s[16:17], 10
    s_cbranch_scc1 L_t10
    s_waitcnt vmcnt(2)
L_t10:
    buffer_load_dwordx4 v[168:171], v2, s[28:31], s38 offen offset:2048 nt
    s_waitcnt vmcnt(3)
    s_bitcmp1_b64 s[16:17], 11
    s_cbranch_scc1 L_t11
    s_waitcnt vmcnt(2)
L_t11:
    buffer_load_dwordx4 v[172:175], v2, s[28:31], s38 offen offset:3072 nt
    s_waitcnt vmcnt(3)
    s_bitcmp1_b64 s[16:17], 12
    s_cbranch_scc1 L_t12
    s_waitcnt vmcnt(2)
L_t12:
    s_add_u32 s38, s38, 32768
    buffer_load_dwordx4 v[176:179], v2, s[28:31], s38 offen offset:0 nt
    s_waitcnt vmcnt(3)
    s_bitcmp1_b64 s[16:17], 13
    s_cbranch_scc1 L_t13
    s_waitcnt vmcnt(2)
L_t13:
    buffer_load_dwordx4 v[180:183], v2, s[28:31], s38 offen offset:1024 nt
    s_waitcnt vmcnt(3)
    s_bitcmp1_b64 s[16:17], 14
    s_cbranch_scc1 L_t14
    s_waitcnt vmcnt(2)
L_t14:
    buffer_load_dwordx4 v[184:187], v2, s[28:31], s38 offen offset:2048 nt
    s_waitcnt vmcnt(3)
    s_bitcmp1_b64 s[16:17], 15
    s_cbranch_scc1 L_t15
    s_waitcnt vmcnt(2)
L_t15:
    buffer_load_dwordx4 v[188:191], v2, s[28:31], s38 offen offset:3072 nt
    s_waitcnt vmcnt(3)
    s_bitcmp1_b64 s[16:17], 16
    s_cbranch_scc1 L_t16
    s_waitcnt vmcnt(2)
L_t16:
    s_add_u32 s38, s38, 32768
    buffer_load_dwordx4 v[192:195], v2, s[28:31], s38 offen offset:0 nt
    s_waitcnt vmcnt(3)
    s_bitcmp1_b64 s[16:17], 17
    s_cbranch_scc1 L_t17
    s_waitcnt vmcnt(2)
L_t17:
    buffer_load_dwordx4 v[196:199], v2, s[28:31], s38 offen offset:1024 nt
    s_waitcnt vmcnt(3)
    s_bitcmp1_b64 s[16:17], 18
    s_cbranch_scc1 L_t18
    s_waitcnt vmcnt(2)
L_t18:
    buffer_load_dwordx4 v[200:203], v2, s[28:31], s38 offen offset:2048 nt
    s_waitcnt vmcnt(2)
    global_load_dwordx4 v[88:91], v51, s[26:27]
    s_bitcmp1_b64 s[16:17], 19
    s_cbranch_scc1 L_t19
    s_waitcnt vmcnt(2)
L_t19:
    buffer_load_dwordx4 v[204:207], v2, s[28:31], s38 offen offset:3072 nt
    s_waitcnt vmcnt(3)
    s_bitcmp1_b64 s[16:17], 20
    s_cbranch_scc1 L_t20
    s_waitcnt vmcnt(2)
L_t20:
    s_add_u32 s38, s38, 32768
    buffer_load_dwordx4 v[208:211], v2, s[28:31], s38 offen offset:0 nt
    s_waitcnt vmcnt(3)
    s_bitcmp1_b64 s[16:17], 21
    s_cbranch_scc1 L_t21
    s_waitcnt vmcnt(2)
L_t21:
    buffer_load_dwordx4 v[212:215], v2, s[28:31], s38 offen offset:1024 nt
    s_waitcnt vmcnt(3)
    s_bitcmp1_b64 s[16:17], 22
    s_cbranch_scc1 L_t22
    s_waitcnt vmcnt(2)
L_t22:
    buffer_load_dwordx4 v[216:219], v2, s[28:31], s38 offen offset:2048 nt
    s_mov_b32 s48, 0
L_qchk:
    v_bitop3_b32 v53, v88, v89, s15 bitop3:0x7e
    v_bitop3_b32 v54, v90, v91, s15 bitop3:0x7e
    v_bitop3_b32 v53, v53, v54, s100 bitop3:0xa8
    v_cmp_ne_u32 vcc, 0, v53
    s_cbranch_vccz L_qok
    s_add_u32 s48, s48, 1
    s_cmp_gt_u32 s48, 131072
    s_cbranch_scc1 L_qok
    s_sleep 2
    global_load_dwordx4 v[88:91], v51, s[26:27] sc1
    s_waitcnt vmcnt(0)
    s_branch L_qchk
L_qok:
    v_permlane32_swap_b32 v88, v90
    v_permlane32_swap_b32 v89, v91
    v_add_f32 v88, v88, v90
    v_add_f32 v89, v89, v91
    s_nop 1
    v_permlane16_swap_b32 v88, v89
    v_add_f32 v88, v88, v89
    v_mov_b32 v53, 1
    v_cvt_pk_bf16_f32 v88, v88, v88
    ds_write_b16 v52, v88 offset:1024
    s_mov_b64 exec, 1
    ds_add_u32 v5, v53 offset:4
    s_mov_b64 exec, -1
    s_waitcnt vmcnt(3)
    s_bitcmp1_b64 s[16:17], 23
    s_cbranch_scc1 L_t23
    s_waitcnt vmcnt(2)
L_t23:
    buffer_load_dwordx4 v[220:223], v2, s[28:31], s38 offen offset:3072 nt
    s_waitcnt vmcnt(3)
    s_bitcmp1_b64 s[16:17], 24
    s_cbranch_scc1 L_t24
    s_waitcnt vmcnt(2)
L_t24:
    s_add_u32 s38, s38, 32768
    buffer_load_dwordx4 v[224:227], v2, s[28:31], s38 offen offset:0 nt
    s_waitcnt vmcnt(3)
    s_bitcmp1_b64 s[16:17], 25
    s_cbranch_scc1 L_t25
    s_waitcnt vmcnt(2)
L_t25:
    buffer_load_dwordx4 v[228:231], v2, s[28:31], s38 offen offset:1024 nt
    s_waitcnt vmcnt(3)
    s_bitcmp1_b64 s[16:17], 26
    s_cbranch_scc1 L_t26
    s_waitcnt vmcnt(2)
L_t26:
    buffer_load_dwordx4 v[232:235], v2, s[28:31], s38 offen offset:2048 nt
    s_waitcnt vmcnt(3)
    s_bitcmp1_b64 s[16:17], 27
    s_cbranch_scc1 L_t27
    s_waitcnt vmcnt(2)
L_t27:
    buffer_load_dwordx4 v[236:239], v2, s[28:31], s38 offen offset:3072 nt
    s_waitcnt vmcnt(3)
    s_bitcmp1_b64 s[16:17], 28
    s_cbranch_scc1 L_t28
    s_waitcnt vmcnt(2)
L_t28:
    s_add_u32 s38, s38, 32768
    buffer_load_dwordx4 v[240:243], v2, s[28:31], s38 offen offset:0 nt
    s_waitcnt vmcnt(3)
    s_bitcmp1_b64 s[16:17], 29
    s_cbranch_scc1 L_t29
    s_waitcnt vmcnt(2)
L_t29:
    buffer_load_dwordx4 v[244:247], v2, s[28:31], s38 offen offset:1024 nt
    s_waitcnt vmcnt(3)
    s_bitcmp1_b64 s[16:17], 30
    s_cbranch_scc1 L_t30
    s_waitcnt vmcnt(2)
L_t30:
    buffer_load_dwordx4 v[248:251], v2, s[28:31], s38 offen offset:2048 nt
    s_waitcnt vmcnt(3)
    s_bitcmp1_b64 s[16:17], 31
    s_cbranch_scc1 L_t31
    s_waitcnt vmcnt(2)
L_t31:
    buffer_load_dwordx4 v[252:255], v2, s[28:31], s38 offen offset:3072 nt
    s_waitcnt vmcnt(3)
    s_bitcmp1_b64 s[16:17], 32
    s_cbranch_scc1 L_t32
    s_waitcnt vmcnt(2)
L_t32:
    buffer_load_dwordx4 v[56:59], v3, s[32:35], s39 offen offset:0 nt
    s_getreg_b32 s52, hwreg(HW_REG_XCC_ID, 0, 4)
    s_lshl_b32 s52, s52, 8
    s_or_b32 s52, s52, s15
    s_mov_b32 s45, 0x3fb8aa3b
    s_mov_b32 s46, 0x3db504f3
    v_bfe_u32 v46, v1, 2, 1
    v_lshlrev_b32 v46, 4, v46
    v_mov_b32 v47, 0xffff
    v_lshlrev_b32 v4, v46, v47
    v_and_b32 v46, 1, v1
    v_lshlrev_b32 v46, 4, v46
    v_lshlrev_b32 v48, v46, v47
    v_bfe_u32 v46, v1, 1, 3
    v_cmp_eq_u32 vcc, 0, v46
    s_nop 1
    v_cndmask_b32 v6, 0, v48, vcc
    v_cmp_eq_u32 vcc, 1, v46
    s_nop 1
    v_cndmask_b32 v7, 0, v48, vcc
    v_cmp_eq_u32 vcc, 2, v46
    s_nop 1
    v_cndmask_b32 v8, 0, v48, vcc
    v_cmp_eq_u32 vcc, 3, v46
    s_nop 1
    v_cndmask_b32 v9, 0, v48, vcc
    v_cmp_eq_u32 vcc, 4, v46
    s_nop 1
    v_cndmask_b32 v10, 0, v48, vcc
    v_cmp_eq_u32 vcc, 5, v46
    s_nop 1
    v_cndmask_b32 v11, 0, v48, vcc
    v_cmp_eq_u32 vcc, 6, v46
    s_nop 1
    v_cndmask_b32 v12, 0, v48, vcc
    v_cmp_eq_u32 vcc, 7, v46
    s_nop 1
    v_cndmask_b32 v13, 0, v48, vcc
    s_waitcnt vmcnt(3)
    s_bitcmp1_b64 s[16:17], 33
    s_cbranch_scc1 L_t33
    s_waitcnt vmcnt(2)
L_t33:
    buffer_load_dwordx4 v[60:63], v3, s[32:35], s39 offen offset:1024 nt
    v_lshrrev_b32 v54, 4, v1
    v_and_b32 v55, 15, v1
    v_lshlrev_b32 v55, 4, v55
    s_lshl_b32 s40, s36, 3
    s_add_u32 s40, s40, s3
    s_lshl_b32 s40, s40, 5
    s_add_u32 s40, s40, s37
    s_lshl_b32 s40, s40, 8
    s_add_u32 s40, s40, 0x400000
    v_lshl_add_u32 v14, v54, 2, v55
    v_add_u32 v14, s40, v14
    v_and_b32 v48, 0x70, v55
    v_lshl_add_u32 v15, v54, 2, v48
    s_lshl_b32 s40, s51, 3
    s_add_u32 s40, s40, s3
    s_lshl_b32 s40, s40, 13
    s_lshl_b32 s41, s47, 7
    s_add_u32 s40, s40, s41
    s_add_u32 s40, s40, 0x80000
    v_add_u32 v15, s40, v15
    s_waitcnt vmcnt(3)
    s_bitcmp1_b64 s[16:17], 34
    s_cbranch_scc1 L_t34
    s_waitcnt vmcnt(2)
L_t34:
    buffer_load_dwordx4 v[64:67], v3, s[32:35], s39 offen offset:2048 nt
    s_lshr_b32 s40, s47, 1
    s_lshl_b32 s40, s40, 7
    s_lshr_b32 s41, s3, 1
    s_lshl_b32 s41, s41, 5
    s_add_u32 s40, s40, s41
    s_and_b32 s41, s47, 1
    s_lshl_b32 s41, s41, 2
    s_add_u32 s40, s40, s41
    s_and_b32 s41, s3, 1
    s_lshl_b32 s41, s41, 1
    s_add_u32 s40, s40, s41
    s_lshl_b32 s40, s40, 10
    s_lshl_b32 s41, s51, 8
    s_add_u32 s40, s40, s41
    v_lshl_add_u32 v46, v54, 13, v55
    v_add_u32 v46, s40, v46
    s_mul_i32 s40, s47, 28
    s_min_u32 s42, s3, 6
    s_lshl_b32 s42, s42, 2
    s_add_u32 s40, s40, s42
    s_lshl_b32 s42, s40, 10
    s_add_u32 s42, s42, s41
    v_lshl_add_u32 v47, v54, 10, v55
    v_add_u32 v47, s42, v47
    v_add_u32 v55, s40, v54
    v_lshrrev_b32 v48, 6, v55
    v_lshlrev_b32 v48, 11, v48
    v_and_b32 v55, 63, v55
    v_lshl_add_u32 v48, v55, 2, v48
    v_and_b32 v55, 7, v1
    v_lshl_add_u32 v48, v55, 8, v48
    v_add_u32 v48, 0x10000, v48
    s_waitcnt vmcnt(3)
    s_bitcmp1_b64 s[16:17], 35
    s_cbranch_scc1 L_t35
    s_waitcnt vmcnt(2)
L_t35:
    buffer_load_dwordx4 v[68:71], v3, s[32:35], s39 offen offset:3072 nt
    v_add_u32 v49, s3, v1
    v_and_b32 v49, 7, v49
    v_lshl_add_u32 v49, v49, 2, v54
    v_lshlrev_b32 v49, 7, v49
    s_lshl_b32 s40, s36, 12
    s_lshr_b32 s41, s37, 3
    s_lshl_b32 s41, s41, 4
    s_add_u32 s40, s40, s41
    s_add_u32 s40, s40, 0x20000
    v_add_u32 v49, s40, v49
    s_lshl_b32 s40, s47, 3
    s_add_u32 s40, s40, s3
    s_lshl_b32 s40, s40, 10
    s_add_u32 s40, s40, 0x400000
    v_add_u32 v50, s40, v3
    s_and_b32 s40, s2, 15
    s_lshl_b32 s40, s40, 5
    v_lshl_add_u32 v52, v54, 3, v55
    v_add_lshl_u32 v52, v52, s40, 1
    v_and_b32 v51, 3, v1
    v_lshlrev_b32 v51, 9, v51
    v_lshl_add_u32 v51, v54, 6, v51
    v_bfe_u32 v55, v1, 2, 2
    v_lshl_add_u32 v51, v55, 4, v51
    v_and_b32 v53, 3, v1
    v_lshlrev_b32 v53, 8, v53
    v_lshl_add_u32 v53, v54, 6, v53
    v_lshl_add_u32 v53, v55, 4, v53
    s_lshl_b32 s40, s3, 11
    v_add_u32 v51, s40, v51
    s_waitcnt vmcnt(2)
    global_load_dwordx4 v[28:31], v50, s[26:27] sc1
    s_bitcmp1_b64 s[16:17], 36
    s_cbranch_scc1 L_t36
    s_waitcnt vmcnt(2)
L_t36:
    s_add_u32 s39, s39, 32768
    buffer_load_dwordx4 v[72:75], v3, s[32:35], s39 offen offset:0 nt
    s_waitcnt vmcnt(3)
    s_bitcmp1_b64 s[16:17], 37
    s_cbranch_scc1 L_t37
    s_waitcnt vmcnt(2)
L_t37:
    buffer_load_dwordx4 v[76:79], v3, s[32:35], s39 offen offset:1024 nt
    s_mov_b32 s48, 0
L_qw:
    ds_read_b32 v54, v5 offset:4
    s_waitcnt lgkmcnt(0)
    v_readfirstlane_b32 s40, v54
    s_cmp_eq_u32 s40, 8
    s_cbranch_scc1 L_qw_ok
    s_add_u32 s48, s48, 1
    s_cmp_gt_u32 s48, 2097152
    s_cbranch_scc1 L_qw_ok
    s_sleep 1
    s_branch L_qw
L_qw_ok:
    ds_read_b128 v[16:19], v53 offset:1024
    s_waitcnt lgkmcnt(0)
    v_mfma_f32_16x16x32_bf16 v[128:131], v[128:131], v[16:19], 0
    v_mfma_f32_16x16x32_bf16 v[144:147], v[144:147], v[16:19], 0
    v_mfma_f32_16x16x32_bf16 v[160:163], v[160:163], v[16:19], 0
    v_mfma_f32_16x16x32_bf16 v[176:179], v[176:179], v[16:19], 0
    v_mfma_f32_16x16x32_bf16 v[192:195], v[192:195], v[16:19], 0
    v_mfma_f32_16x16x32_bf16 v[208:211], v[208:211], v[16:19], 0
    v_mfma_f32_16x16x32_bf16 v[224:227], v[224:227], v[16:19], 0
    v_mfma_f32_16x16x32_bf16 v[240:243], v[240:243], v[16:19], 0
    s_nop 0
    v_mov_b32_dpp v20, v128 quad_perm:[0,1,2,3] row_mask:0xf bank_mask:0x1
    v_mov_b32_dpp v21, v144 quad_perm:[0,1,2,3] row_mask:0xf bank_mask:0x1
    v_mov_b32_dpp v22, v160 quad_perm:[0,1,2,3] row_mask:0xf bank_mask:0x1
    v_mov_b32_dpp v23, v176 quad_perm:[0,1,2,3] row_mask:0xf bank_mask:0x1
    v_mfma_f32_16x16x32_bf16 v[132:135], v[132:135], v[16:19], 0
    v_mov_b32_dpp v24, v192 quad_perm:[0,1,2,3] row_mask:0xf bank_mask:0x1
    v_mov_b32_dpp v25, v208 quad_perm:[0,1,2,3] row_mask:0xf bank_mask:0x1
    v_mov_b32_dpp v26, v224 quad_perm:[0,1,2,3] row_mask:0xf bank_mask:0x1
    v_mov_b32_dpp v27, v240 quad_perm:[0,1,2,3] row_mask:0xf bank_mask:0x1
    v_mfma_f32_16x16x32_bf16 v[148:151], v[148:151], v[16:19], 0
    v_add_f32_dpp v20, v129, v20 row_ror:12 row_mask:0xf bank_mask:0x1
    v_add_f32_dpp v21, v145, v21 row_ror:12 row_mask:0xf bank_mask:0x1
    v_add_f32_dpp v22, v161, v22 row_ror:12 row_mask:0xf bank_mask:0x1
    v_add_f32_dpp v23, v177, v23 row_ror:12 row_mask:0xf bank_mask:0x1
    v_mfma_f32_16x16x32_bf16 v[164:167], v[164:167], v[16:19], 0
    v_add_f32_dpp v24, v193, v24 row_ror:12 row_mask:0xf bank_mask:0x1
    v_add_f32_dpp v25, v209, v25 row_ror:12 row_mask:0xf bank_mask:0x1
    v_add_f32_dpp v26, v225, v26 row_ror:12 row_mask:0xf bank_mask:0x1
    v_add_f32_dpp v27, v241, v27 row_ror:12 row_mask:0xf bank_mask:0x1
    v_mfma_f32_16x16x32_bf16 v[180:183], v[180:183], v[16:19], 0
    s_waitcnt vmcnt(3)
    s_bitcmp1_b64 s[16:17], 38
    s_cbranch_scc1 L_t38
    s_waitcnt vmcnt(2)
L_t38:
    buffer_load_dwordx4 v[80:83], v3, s[32:35], s39 offen offset:2048 nt
    v_add_f32_dpp v20, v130, v20 row_ror:8 row_mask:0xf bank_mask:0x1
    v_add_f32_dpp v21, v146, v21 row_ror:8 row_mask:0xf bank_mask:0x1
    v_add_f32_dpp v22, v162, v22 row_ror:8 row_mask:0xf bank_mask:0x1
    v_add_f32_dpp v23, v178, v23 row_ror:8 row_mask:0xf bank_mask:0x1
    v_mfma_f32_16x16x32_bf16 v[196:199], v[196:199], v[16:19], 0
    v_add_f32_dpp v24, v194, v24 row_ror:8 row_mask:0xf bank_mask:0x1
    v_add_f32_dpp v25, v210, v25 row_ror:8 row_mask:0xf bank_mask:0x1
    v_add_f32_dpp v26, v226, v26 row_ror:8 row_mask:0xf bank_mask:0x1
    v_add_f32_dpp v27, v242, v27 row_ror:8 row_mask:0xf bank_mask:0x1
    v_mfma_f32_16x16x32_bf16 v[212:215], v[212:215], v[16:19], 0
    v_add_f32_dpp v20, v131, v20 row_ror:4 row_mask:0xf bank_mask:0x1
    v_add_f32_dpp v21, v147, v21 row_ror:4 row_mask:0xf bank_mask:0x1
    v_add_f32_dpp v22, v163, v22 row_ror:4 row_mask:0xf bank_mask:0x1
    v_add_f32_dpp v23, v179, v23 row_ror:4 row_mask:0xf bank_mask:0x1
    v_mfma_f32_16x16x32_bf16 v[228:231], v[228:231], v[16:19], 0
    v_add_f32_dpp v24, v195, v24 row_ror:4 row_mask:0xf bank_mask:0x1
    v_add_f32_dpp v25, v211, v25 row_ror:4 row_mask:0xf bank_mask:0x1
    v_add_f32_dpp v26, v227, v26 row_ror:4 row_mask:0xf bank_mask:0x1
    v_add_f32_dpp v27, v243, v27 row_ror:4 row_mask:0xf bank_mask:0x1
    v_mfma_f32_16x16x32_bf16 v[244:247], v[244:247], v[16:19], 0
    s_waitcnt vmcnt(3)
    s_bitcmp1_b64 s[16:17], 39
    s_cbranch_scc1 L_t39
    s_waitcnt vmcnt(2)
L_t39:
    buffer_load_dwordx4 v[84:87], v3, s[32:35], s39 offen offset:3072 nt
    v_mov_b32_dpp v20, v132 row_ror:4 row_mask:0xf bank_mask:0x2
    v_mov_b32_dpp v21, v148 row_ror:4 row_mask:0xf bank_mask:0x2
    v_mov_b32_dpp v22, v164 row_ror:4 row_mask:0xf bank_mask:0x2
    v_mov_b32_dpp v23, v180 row_ror:4 row_mask:0xf bank_mask:0x2
    v_mfma_f32_16x16x32_bf16 v[136:139], v[136:139], v[16:19], 0
    v_mov_b32_dpp v24, v196 row_ror:4 row_mask:0xf bank_mask:0x2
    v_mov_b32_dpp v25, v212 row_ror:4 row_mask:0xf bank_mask:0x2
    v_mov_b32_dpp v26, v228 row_ror:4 row_mask:0xf bank_mask:0x2
    v_mov_b32_dpp v27, v244 row_ror:4 row_mask:0xf bank_mask:0x2
    v_mfma_f32_16x16x32_bf16 v[152:155], v[152:155], v[16:19], 0
    v_add_f32_dpp v20, v133, v20 quad_perm:[0,1,2,3] row_mask:0xf bank_mask:0x2
    v_add_f32_dpp v21, v149, v21 quad_perm:[0,1,2,3] row_mask:0xf bank_mask:0x2
    v_add_f32_dpp v22, v165, v22 quad_perm:[0,1,2,3] row_mask:0xf bank_mask:0x2
    v_add_f32_dpp v23, v181, v23 quad_perm:[0,1,2,3] row_mask:0xf bank_mask:0x2
    v_mfma_f32_16x16x32_bf16 v[168:171], v[168:171], v[16:19], 0
    v_add_f32_dpp v24, v197, v24 quad_perm:[0,1,2,3] row_mask:0xf bank_mask:0x2
    v_add_f32_dpp v25, v213, v25 quad_perm:[0,1,2,3] row_mask:0xf bank_mask:0x2
    v_add_f32_dpp v26, v229, v26 quad_perm:[0,1,2,3] row_mask:0xf bank_mask:0x2
    v_add_f32_dpp v27, v245, v27 quad_perm:[0,1,2,3] row_mask:0xf bank_mask:0x2
    v_mfma_f32_16x16x32_bf16 v[184:187], v[184:187], v[16:19], 0
    s_waitcnt vmcnt(3)
    s_bitcmp1_b64 s[16:17], 40
    s_cbranch_scc1 L_t40
    s_waitcnt vmcnt(2)
L_t40:
    s_add_u32 s39, s39, 32768
    buffer_load_dwordx4 v[88:91], v3, s[32:35], s39 offen offset:0 nt
    v_add_f32_dpp v20, v134, v20 row_ror:12 row_mask:0xf bank_mask:0x2
    v_add_f32_dpp v21, v150, v21 row_ror:12 row_mask:0xf bank_mask:0x2
    v_add_f32_dpp v22, v166, v22 row_ror:12 row_mask:0xf bank_mask:0x2
    v_add_f32_dpp v23, v182, v23 row_ror:12 row_mask:0xf bank_mask:0x2
    v_mfma_f32_16x16x32_bf16 v[200:203], v[200:203], v[16:19], 0
    v_add_f32_dpp v24, v198, v24 row_ror:12 row_mask:0xf bank_mask:0x2
    v_add_f32_dpp v25, v214, v25 row_ror:12 row_mask:0xf bank_mask:0x2
    v_add_f32_dpp v26, v230, v26 row_ror:12 row_mask:0xf bank_mask:0x2
    v_add_f32_dpp v27, v246, v27 row_ror:12 row_mask:0xf bank_mask:0x2
    v_mfma_f32_16x16x32_bf16 v[216:219], v[216:219], v[16:19], 0
    v_add_f32_dpp v20, v135, v20 row_ror:8 row_mask:0xf bank_mask:0x2
    v_add_f32_dpp v21, v151, v21 row_ror:8 row_mask:0xf bank_mask:0x2
    v_add_f32_dpp v22, v167, v22 row_ror:8 row_mask:0xf bank_mask:0x2
    v_add_f32_dpp v23, v183, v23 row_ror:8 row_mask:0xf bank_mask:0x2
    v_mfma_f32_16x16x32_bf16 v[232:235], v[232:235], v[16:19], 0
    v_add_f32_dpp v24, v199, v24 row_ror:8 row_mask:0xf bank_mask:0x2
    v_add_f32_dpp v25, v215, v25 row_ror:8 row_mask:0xf bank_mask:0x2
    v_add_f32_dpp v26, v231, v26 row_ror:8 row_mask:0xf bank_mask:0x2
    v_add_f32_dpp v27, v247, v27 row_ror:8 row_mask:0xf bank_mask:0x2
    v_mfma_f32_16x16x32_bf16 v[248:251], v[248:251], v[16:19], 0
    s_waitcnt vmcnt(3)
    s_bitcmp1_b64 s[16:17], 41
    s_cbranch_scc1 L_t41
    s_waitcnt vmcnt(2)
L_t41:
    buffer_load_dwordx4 v[92:95], v3, s[32:35], s39 offen offset:1024 nt
    v_mov_b32_dpp v20, v136 row_ror:8 row_mask:0xf bank_mask:0x4
    v_mov_b32_dpp v21, v152 row_ror:8 row_mask:0xf bank_mask:0x4
    v_mov_b32_dpp v22, v168 row_ror:8 row_mask:0xf bank_mask:0x4
    v_mov_b32_dpp v23, v184 row_ror:8 row_mask:0xf bank_mask:0x4
    v_mfma_f32_16x16x32_bf16 v[140:143], v[140:143], v[16:19], 0
    v_mov_b32_dpp v24, v200 row_ror:8 row_mask:0xf bank_mask:0x4
    v_mov_b32_dpp v25, v216 row_ror:8 row_mask:0xf bank_mask:0x4
    v_mov_b32_dpp v26, v232 row_ror:8 row_mask:0xf bank_mask:0x4
    v_mov_b32_dpp v27, v248 row_ror:8 row_mask:0xf bank_mask:0x4
    v_mfma_f32_16x16x32_bf16 v[156:159], v[156:159], v[16:19], 0
    v_add_f32_dpp v20, v137, v20 row_ror:4 row_mask:0xf bank_mask:0x4
    v_add_f32_dpp v21, v153, v21 row_ror:4 row_mask:0xf bank_mask:0x4
    v_add_f32_dpp v22, v169, v22 row_ror:4 row_mask:0xf bank_mask:0x4
    v_add_f32_dpp v23, v185, v23 row_ror:4 row_mask:0xf bank_mask:0x4
    v_mfma_f32_16x16x32_bf16 v[172:175], v[172:175], v[16:19], 0
    v_add_f32_dpp v24, v201, v24 row_ror:4 row_mask:0xf bank_mask:0x4
    v_add_f32_dpp v25, v217, v25 row_ror:4 row_mask:0xf bank_mask:0x4
    v_add_f32_dpp v26, v233, v26 row_ror:4 row_mask:0xf bank_mask:0x4
    v_add_f32_dpp v27, v249, v27 row_ror:4 row_mask:0xf bank_mask:0x4
    v_mfma_f32_16x16x32_bf16 v[188:191], v[188:191], v[16:19], 0
    s_waitcnt vmcnt(3)
    s_bitcmp1_b64 s[16:17], 42
    s_cbranch_scc1 L_t42
    s_waitcnt vmcnt(2)
L_t42:
    buffer_load_dwordx4 v[96:99], v3, s[32:35], s39 offen offset:2048 nt
    v_add_f32_dpp v20, v138, v20 quad_perm:[0,1,2,3] row_mask:0xf bank_mask:0x4
    v_add_f32_dpp v21, v154, v21 quad_perm:[0,1,2,3] row_mask:0xf bank_mask:0x4
    v_add_f32_dpp v22, v170, v22 quad_perm:[0,1,2,3] row_mask:0xf bank_mask:0x4
    v_add_f32_dpp v23, v186, v23 quad_perm:[0,1,2,3] row_mask:0xf bank_mask:0x4
    v_mfma_f32_16x16x32_bf16 v[204:207], v[204:207], v[16:19], 0
    v_add_f32_dpp v24, v202, v24 quad_perm:[0,1,2,3] row_mask:0xf bank_mask:0x4
    v_add_f32_dpp v25, v218, v25 quad_perm:[0,1,2,3] row_mask:0xf bank_mask:0x4
    v_add_f32_dpp v26, v234, v26 quad_perm:[0,1,2,3] row_mask:0xf bank_mask:0x4
    v_add_f32_dpp v27, v250, v27 quad_perm:[0,1,2,3] row_mask:0xf bank_mask:0x4
    v_mfma_f32_16x16x32_bf16 v[220:223], v[220:223], v[16:19], 0
    v_add_f32_dpp v20, v139, v20 row_ror:12 row_mask:0xf bank_mask:0x4
    v_add_f32_dpp v21, v155, v21 row_ror:12 row_mask:0xf bank_mask:0x4
    v_add_f32_dpp v22, v171, v22 row_ror:12 row_mask:0xf bank_mask:0x4
    v_add_f32_dpp v23, v187, v23 row_ror:12 row_mask:0xf bank_mask:0x4
    v_mfma_f32_16x16x32_bf16 v[236:239], v[236:239], v[16:19], 0
    v_add_f32_dpp v24, v203, v24 row_ror:12 row_mask:0xf bank_mask:0x4
    v_add_f32_dpp v25, v219, v25 row_ror:12 row_mask:0xf bank_mask:0x4
    v_add_f32_dpp v26, v235, v26 row_ror:12 row_mask:0xf bank_mask:0x4
    v_add_f32_dpp v27, v251, v27 row_ror:12 row_mask:0xf bank_mask:0x4
    v_mfma_f32_16x16x32_bf16 v[252:255], v[252:255], v[16:19], 0
    s_waitcnt vmcnt(3)
    s_bitcmp1_b64 s[16:17], 43
    s_cbranch_scc1 L_t43
    s_waitcnt vmcnt(2)
L_t43:
    buffer_load_dwordx4 v[100:103], v3, s[32:35], s39 offen offset:3072 nt
    v_mov_b32_dpp v20, v140 row_ror:12 row_mask:0xf bank_mask:0x8
    v_mov_b32_dpp v21, v156 row_ror:12 row_mask:0xf bank_mask:0x8
    v_mov_b32_dpp v22, v172 row_ror:12 row_mask:0xf bank_mask:0x8
    v_mov_b32_dpp v23, v188 row_ror:12 row_mask:0xf bank_mask:0x8
    v_mov_b32_dpp v24, v204 row_ror:12 row_mask:0xf bank_mask:0x8
    v_mov_b32_dpp v25, v220 row_ror:12 row_mask:0xf bank_mask:0x8
    v_mov_b32_dpp v26, v236 row_ror:12 row_mask:0xf bank_mask:0x8
    v_mov_b32_dpp v27, v252 row_ror:12 row_mask:0xf bank_mask:0x8
    v_add_f32_dpp v20, v141, v20 row_ror:8 row_mask:0xf bank_mask:0x8
    v_add_f32_dpp v21, v157, v21 row_ror:8 row_mask:0xf bank_mask:0x8
    v_add_f32_dpp v22, v173, v22 row_ror:8 row_mask:0xf bank_mask:0x8
    v_add_f32_dpp v23, v189, v23 row_ror:8 row_mask:0xf bank_mask:0x8
    v_add_f32_dpp v24, v205, v24 row_ror:8 row_mask:0xf bank_mask:0x8
    v_add_f32_dpp v25, v221, v25 row_ror:8 row_mask:0xf bank_mask:0x8
    v_add_f32_dpp v26, v237, v26 row_ror:8 row_mask:0xf bank_mask:0x8
    v_add_f32_dpp v27, v253, v27 row_ror:8 row_mask:0xf bank_mask:0x8
    s_waitcnt vmcnt(3)
    s_bitcmp1_b64 s[16:17], 44
    s_cbranch_scc1 L_t44
    s_waitcnt vmcnt(2)
L_t44:
    s_add_u32 s39, s39, 32768
    buffer_load_dwordx4 v[104:107], v3, s[32:35], s39 offen offset:0 nt
    v_add_f32_dpp v20, v142, v20 row_ror:4 row_mask:0xf bank_mask:0x8
    v_add_f32_dpp v21, v158, v21 row_ror:4 row_mask:0xf bank_mask:0x8
    v_add_f32_dpp v22, v174, v22 row_ror:4 row_mask:0xf bank_mask:0x8
    v_add_f32_dpp v23, v190, v23 row_ror:4 row_mask:0xf bank_mask:0x8
    v_add_f32_dpp v24, v206, v24 row_ror:4 row_mask:0xf bank_mask:0x8
    v_add_f32_dpp v25, v222, v25 row_ror:4 row_mask:0xf bank_mask:0x8
    v_add_f32_dpp v26, v238, v26 row_ror:4 row_mask:0xf bank_mask:0x8
    v_add_f32_dpp v27, v254, v27 row_ror:4 row_mask:0xf bank_mask:0x8
    v_add_f32_dpp v20, v143, v20 quad_perm:[0,1,2,3] row_mask:0xf bank_mask:0x8
    v_add_f32_dpp v21, v159, v21 quad_perm:[0,1,2,3] row_mask:0xf bank_mask:0x8
    v_add_f32_dpp v22, v175, v22 quad_perm:[0,1,2,3] row_mask:0xf bank_mask:0x8
    v_add_f32_dpp v23, v191, v23 quad_perm:[0,1,2,3] row_mask:0xf bank_mask:0x8
    v_add_f32_dpp v24, v207, v24 quad_perm:[0,1,2,3] row_mask:0xf bank_mask:0x8
    v_add_f32_dpp v25, v223, v25 quad_perm:[0,1,2,3] row_mask:0xf bank_mask:0x8
    v_add_f32_dpp v26, v239, v26 quad_perm:[0,1,2,3] row_mask:0xf bank_mask:0x8
    v_add_f32_dpp v27, v255, v27 quad_perm:[0,1,2,3] row_mask:0xf bank_mask:0x8
    s_waitcnt vmcnt(3)
    s_bitcmp1_b64 s[16:17], 45
    s_cbranch_scc1 L_t45
    s_waitcnt vmcnt(2)
L_t45:
    buffer_load_dwordx4 v[108:111], v3, s[32:35], s39 offen offset:1024 nt
    s_waitcnt vmcnt(3)
    s_bitcmp1_b64 s[16:17], 46
    s_cbranch_scc1 L_t46
    s_waitcnt vmcnt(2)
L_t46:
    buffer_load_dwordx4 v[112:115], v3, s[32:35], s39 offen offset:2048 nt
    v_cvt_pk_bf16_f32 v54, v20, v21
    v_lshlrev_b32 v20, 16, v54
    v_and_b32 v21, s44, v54
    v_mul_f32 v20, s46, v20
    v_mul_f32 v21, s46, v21
    v_cvt_pk_bf16_f32 v54, v20, v21
    v_lshlrev_b32 v20, 16, v54
    v_and_b32 v21, s44, v54
    v_cvt_pk_bf16_f32 v55, v22, v23
    v_lshlrev_b32 v22, 16, v55
    v_and_b32 v23, s44, v55
    v_mul_f32 v22, s46, v22
    v_mul_f32 v23, s46, v23
    v_cvt_pk_bf16_f32 v55, v22, v23
    v_lshlrev_b32 v22, 16, v55
    v_and_b32 v23, s44, v55
    v_cvt_pk_bf16_f32 v54, v24, v25
    v_lshlrev_b32 v24, 16, v54
    v_and_b32 v25, s44, v54
    v_mul_f32 v24, s46, v24
    v_mul_f32 v25, s46, v25
    v_cvt_pk_bf16_f32 v54, v24, v25
    v_lshlrev_b32 v24, 16, v54
    v_and_b32 v25, s44, v54
    v_cvt_pk_bf16_f32 v55, v26, v27
    v_lshlrev_b32 v26, 16, v55
    v_and_b32 v27, s44, v55
    v_mul_f32 v26, s46, v26
    v_mul_f32 v27, s46, v27
    v_cvt_pk_bf16_f32 v55, v26, v27
    v_lshlrev_b32 v26, 16, v55
    v_and_b32 v27, s44, v55
    s_waitcnt vmcnt(3)
    s_bitcmp1_b64 s[16:17], 47
    s_cbranch_scc1 L_t47
    s_waitcnt vmcnt(2)
L_t47:
    buffer_load_dwordx4 v[116:119], v3, s[32:35], s39 offen offset:3072 nt
    v_max3_f32 v172, v20, v21, v22
    v_max3_f32 v174, v23, v24, v25
    v_max3_f32 v172, v172, v26, v27
    v_max_f32 v172, v172, v174
    s_nop 1
    v_max_f32_dpp v172, v172, v172 row_ror:8 row_mask:0xf bank_mask:0xf
    s_nop 1
    v_max_f32_dpp v172, v172, v172 row_ror:4 row_mask:0xf bank_mask:0xf
    v_mov_b32 v174, v172
    s_nop 1
    v_permlane16_swap_b32 v174, v172
    v_max_f32 v172, v174, v172
    v_mov_b32 v174, v172
    s_nop 1
    v_permlane32_swap_b32 v174, v172
    v_max_f32 v172, v174, v172
    v_mul_f32 v175, s45, v172
    v_fma_f32 v20, v20, s45, -v175
    v_fma_f32 v21, v21, s45, -v175
    v_fma_f32 v22, v22, s45, -v175
    v_fma_f32 v23, v23, s45, -v175
    v_fma_f32 v24, v24, s45, -v175
    v_fma_f32 v25, v25, s45, -v175
    v_fma_f32 v26, v26, s45, -v175
    v_fma_f32 v27, v27, s45, -v175
    v_exp_f32 v20, v20
    v_exp_f32 v21, v21
    v_exp_f32 v22, v22
    v_exp_f32 v23, v23
    v_exp_f32 v24, v24
    v_exp_f32 v25, v25
    v_exp_f32 v26, v26
    v_exp_f32 v27, v27
    s_waitcnt vmcnt(3)
    s_bitcmp1_b64 s[16:17], 48
    s_cbranch_scc1 L_t48
    s_waitcnt vmcnt(2)
L_t48:
    s_add_u32 s39, s39, 32768
    buffer_load_dwordx4 v[120:123], v3, s[32:35], s39 offen offset:0 nt
    v_add_f32 v173, v20, v21
    v_add_f32 v174, v22, v23
    v_add_f32 v173, v173, v24
    v_add_f32 v174, v174, v25
    v_add_f32 v173, v173, v26
    v_add_f32 v174, v174, v27
    v_add_f32 v173, v173, v174
    v_cvt_pk_bf16_f32 v20, v20, v20
    v_cvt_pk_bf16_f32 v21, v21, v21
    v_cvt_pk_bf16_f32 v22, v22, v22
    v_cvt_pk_bf16_f32 v23, v23, v23
    v_cvt_pk_bf16_f32 v24, v24, v24
    v_cvt_pk_bf16_f32 v25, v25, v25
    v_cvt_pk_bf16_f32 v26, v26, v26
    v_cvt_pk_bf16_f32 v27, v27, v27
    v_add_f32_dpp v173, v173, v173 row_ror:8 row_mask:0xf bank_mask:0xf
    s_nop 1
    v_add_f32_dpp v173, v173, v173 row_ror:4 row_mask:0xf bank_mask:0xf
    v_mov_b32 v174, v173
    s_nop 1
    v_permlane16_swap_b32 v174, v173
    v_add_f32 v173, v174, v173
    v_mov_b32 v174, v173
    s_nop 1
    v_permlane32_swap_b32 v174, v173
    v_add_f32 v173, v174, v173
    v_lshlrev_b32 v174, 6, v1
    s_lshl_b32 s40, s3, 3
    v_add_u32 v174, s40, v174
    v_mov_b32 v175, 1
    s_mov_b64 exec, 0xf
    ds_write_b64 v174, v[172:173] offset:512
    s_mov_b64 exec, 1
    ds_add_rtn_u32 v175, v5, v175 offset:8
    s_mov_b64 exec, -1
    s_waitcnt vmcnt(3)
    s_bitcmp1_b64 s[16:17], 49
    s_cbranch_scc1 L_t49
    s_waitcnt vmcnt(2)
L_t49:
    buffer_load_dwordx4 v[124:127], v3, s[32:35], s39 offen offset:1024 nt
    v_lshrrev_b32 v54, 4, v1
    v_and_b32 v55, 15, v1
    s_mul_i32 s40, s3, 288
    v_lshl_add_u32 v252, v55, 2, v54
    v_lshl_add_u32 v252, v252, 2, s40
    s_lshl_b32 s40, s3, 8
    v_lshl_add_u32 v255, v55, 4, s40
    v_lshl_add_u32 v254, v1, 2, s40
    v_lshl_add_u32 v255, v54, 12, v255
    s_lshr_b32 s41, s3, 1
    s_lshl_b32 s41, s41, 5
    v_lshl_add_u32 v238, v54, 3, s41
    v_lshrrev_b32 v239, 3, v1
    v_lshlrev_b32 v239, 10, v239
    v_and_b32 v253, 7, v1
    v_lshl_add_u32 v239, v253, 4, v239
    s_lshl_b32 s41, s3, 7
    v_add_u32 v239, s41, v239
    v_and_b32 v253, 7, v1
    v_mul_u32_u24 v253, 288, v253
    v_lshrrev_b32 v55, 3, v55
    v_lshl_add_u32 v55, v55, 2, v54
    s_lshl_b32 s40, s3, 5
    v_lshl_add_u32 v55, v55, 2, s40
    v_add_u32 v253, v253, v55
    s_waitcnt lgkmcnt(0)
    v_readfirstlane_b32 s40, v175
    s_lshl_b32 s41, s40, 2
    s_lshr_b32 s41, 0x94320000, s41
    s_and_b32 s41, s41, 15
    s_bfm_b64 s[16:17], s41, 50
    s_cmp_eq_u32 s40, 7
    s_cbranch_scc0 L_noml
    v_and_b32 v174, 3, v1
    v_lshlrev_b32 v175, 6, v174
    ds_read_b128 v[188:191], v175 offset:512
    ds_read_b128 v[204:207], v175 offset:528
    ds_read_b128 v[220:223], v175 offset:544
    ds_read_b128 v[168:171], v175 offset:560
    s_lshl_b32 s40, s36, 12
    s_lshl_b32 s41, s37, 7
    s_add_u32 s40, s40, s41
    s_add_u32 s40, s40, 0x20000
    v_add_u32 v54, s40, v3
    v_lshlrev_b32 v55, 5, v174
    s_waitcnt lgkmcnt(0)
    v_max3_f32 v172, v188, v190, v204
    v_max3_f32 v172, v172, v206, v220
    v_max3_f32 v172, v172, v222, v168
    v_max_f32 v172, v172, v170
    v_sub_f32 v140, v188, v172
    v_sub_f32 v141, v190, v172
    v_sub_f32 v142, v204, v172
    v_sub_f32 v143, v206, v172
    v_sub_f32 v156, v220, v172
    v_sub_f32 v157, v222, v172
    v_sub_f32 v158, v168, v172
    v_sub_f32 v159, v170, v172
    v_mul_f32 v140, s45, v140
    v_mul_f32 v141, s45, v141
    v_mul_f32 v142, s45, v142
    v_mul_f32 v143, s45, v143
    v_mul_f32 v156, s45, v156
    v_mul_f32 v157, s45, v157
    v_mul_f32 v158, s45, v158
    v_mul_f32 v159, s45, v159
    v_exp_f32 v140, v140
    v_exp_f32 v141, v141
    v_exp_f32 v142, v142
    v_exp_f32 v143, v143
    v_exp_f32 v156, v156
    v_exp_f32 v157, v157
    v_exp_f32 v158, v158
    v_exp_f32 v159, v159
    v_mul_f32 v173, v140, v189
    v_fmac_f32 v173, v141, v191
    v_fmac_f32 v173, v142, v205
    v_fmac_f32 v173, v143, v207
    v_fmac_f32 v173, v156, v221
    v_fmac_f32 v173, v157, v223
    v_fmac_f32 v173, v158, v169
    v_fmac_f32 v173, v159, v171
    v_and_or_b32 v172, v172, s49, v0
    v_and_or_b32 v173, v173, s49, v0
    v_mov_b32 v174, s14
    v_mov_b32 v175, s52
    s_mov_b64 exec, 0xff
    global_store_dwordx4 v54, v[172:175], s[26:27] sc1
    s_mov_b64 exec, 0xf
    ds_write_b128 v55, v[140:143] offset:256
    ds_write_b128 v55, v[156:159] offset:272
    s_mov_b64 exec, -1
L_noml:
    s_nop 1
    v_and_b32_dpp v38, v20, v4 quad_perm:[0,1,2,3] row_mask:0xf bank_mask:0x1
    v_and_b32_dpp v39, v20, v4 row_ror:8 row_mask:0xf bank_mask:0x4
    s_nop 0
    v_and_b32_dpp v38, v20, v4 row_ror:4 row_mask:0xf bank_mask:0x2
    v_and_b32_dpp v39, v20, v4 row_ror:12 row_mask:0xf bank_mask:0x8
    s_waitcnt vmcnt(3)
    s_bitcmp1_b64 s[16:17], 50
    s_cbranch_scc1 L_t50
    s_waitcnt vmcnt(2)
L_t50:
    buffer_load_dwordx4 v[128:131], v3, s[32:35], s39 offen offset:2048 nt
    v_and_b32_dpp v42, v20, v4 row_ror:12 row_mask:0xf bank_mask:0x1
    v_and_b32_dpp v43, v20, v4 row_ror:4 row_mask:0xf bank_mask:0x4
    v_mfma_f32_16x16x32_bf16 v[28:31], v[56:59], v[38:41], 0
    v_and_b32_dpp v42, v20, v4 quad_perm:[0,1,2,3] row_mask:0xf bank_mask:0x2
    v_and_b32_dpp v43, v20, v4 row_ror:8 row_mask:0xf bank_mask:0x8
    v_mfma_f32_16x16x32_bf16 v[32:35], v[56:59], v[36:39], 0
    v_and_b32_dpp v38, v20, v4 row_ror:8 row_mask:0xf bank_mask:0x1
    v_and_b32_dpp v39, v20, v4 quad_perm:[0,1,2,3] row_mask:0xf bank_mask:0x4
    v_mfma_f32_16x16x32_bf16 v[28:31], v[60:63], v[42:45], v[28:31]
    v_and_b32_dpp v38, v20, v4 row_ror:12 row_mask:0xf bank_mask:0x2
    v_and_b32_dpp v39, v20, v4 row_ror:4 row_mask:0xf bank_mask:0x8
    v_mfma_f32_16x16x32_bf16 v[32:35], v[60:63], v[40:43], v[32:35]
    v_and_b32_dpp v42, v20, v4 row_ror:4 row_mask:0xf bank_mask:0x1
    v_and_b32_dpp v43, v20, v4 row_ror:12 row_mask:0xf bank_mask:0x4
    v_mfma_f32_16x16x32_bf16 v[28:31], v[64:67], v[38:41], v[28:31]
    v_and_b32_dpp v42, v20, v4 row_ror:8 row_mask:0xf bank_mask:0x2
    v_and_b32_dpp v43, v20, v4 quad_perm:[0,1,2,3] row_mask:0xf bank_mask:0x8
    v_mfma_f32_16x16x32_bf16 v[32:35], v[64:67], v[36:39], v[32:35]
    s_waitcnt vmcnt(3)
    s_bitcmp1_b64 s[16:17], 51
    s_cbranch_scc1 L_t51
    s_waitcnt vmcnt(2)
L_t51:
    buffer_load_dwordx4 v[144:147], v3, s[32:35], s39 offen offset:3072 nt
    v_and_b32_dpp v38, v21, v4 quad_perm:[0,1,2,3] row_mask:0xf bank_mask:0x1
    v_and_b32_dpp v39, v21, v4 row_ror:8 row_mask:0xf bank_mask:0x4
    v_mfma_f32_16x16x32_bf16 v[28:31], v[68:71], v[42:45], v[28:31]
    v_and_b32_dpp v38, v21, v4 row_ror:4 row_mask:0xf bank_mask:0x2
    v_and_b32_dpp v39, v21, v4 row_ror:12 row_mask:0xf bank_mask:0x8
    v_mfma_f32_16x16x32_bf16 v[32:35], v[68:71], v[40:43], v[32:35]
    v_and_b32_dpp v42, v21, v4 row_ror:12 row_mask:0xf bank_mask:0x1
    v_and_b32_dpp v43, v21, v4 row_ror:4 row_mask:0xf bank_mask:0x4
    v_mfma_f32_16x16x32_bf16 v[28:31], v[72:75], v[38:41], v[28:31]
    v_and_b32_dpp v42, v21, v4 quad_perm:[0,1,2,3] row_mask:0xf bank_mask:0x2
    v_and_b32_dpp v43, v21, v4 row_ror:8 row_mask:0xf bank_mask:0x8
    v_mfma_f32_16x16x32_bf16 v[32:35], v[72:75], v[36:39], v[32:35]
    v_and_b32_dpp v38, v21, v4 row_ror:8 row_mask:0xf bank_mask:0x1
    v_and_b32_dpp v39, v21, v4 quad_perm:[0,1,2,3] row_mask:0xf bank_mask:0x4
    v_mfma_f32_16x16x32_bf16 v[28:31], v[76:79], v[42:45], v[28:31]
    v_and_b32_dpp v38, v21, v4 row_ror:12 row_mask:0xf bank_mask:0x2
    v_and_b32_dpp v39, v21, v4 row_ror:4 row_mask:0xf bank_mask:0x8
    v_mfma_f32_16x16x32_bf16 v[32:35], v[76:79], v[40:43], v[32:35]
    s_waitcnt vmcnt(3)
    s_bitcmp1_b64 s[16:17], 52
    s_cbranch_scc1 L_t52
    s_waitcnt vmcnt(2)
L_t52:
    s_add_u32 s39, s39, 32768
    buffer_load_dwordx4 v[160:163], v3, s[32:35], s39 offen offset:0 nt
    v_and_b32_dpp v42, v21, v4 row_ror:4 row_mask:0xf bank_mask:0x1
    v_and_b32_dpp v43, v21, v4 row_ror:12 row_mask:0xf bank_mask:0x4
    v_mfma_f32_16x16x32_bf16 v[28:31], v[80:83], v[38:41], v[28:31]
    v_and_b32_dpp v42, v21, v4 row_ror:8 row_mask:0xf bank_mask:0x2
    v_and_b32_dpp v43, v21, v4 quad_perm:[0,1,2,3] row_mask:0xf bank_mask:0x8
    v_mfma_f32_16x16x32_bf16 v[32:35], v[80:83], v[36:39], v[32:35]
    v_and_b32_dpp v38, v22, v4 quad_perm:[0,1,2,3] row_mask:0xf bank_mask:0x1
    v_and_b32_dpp v39, v22, v4 row_ror:8 row_mask:0xf bank_mask:0x4
    v_mfma_f32_16x16x32_bf16 v[28:31], v[84:87], v[42:45], v[28:31]
    v_and_b32_dpp v38, v22, v4 row_ror:4 row_mask:0xf bank_mask:0x2
    v_and_b32_dpp v39, v22, v4 row_ror:12 row_mask:0xf bank_mask:0x8
    v_mfma_f32_16x16x32_bf16 v[32:35], v[84:87], v[40:43], v[32:35]
    v_and_b32_dpp v42, v22, v4 row_ror:12 row_mask:0xf bank_mask:0x1
    v_and_b32_dpp v43, v22, v4 row_ror:4 row_mask:0xf bank_mask:0x4
    v_mfma_f32_16x16x32_bf16 v[28:31], v[88:91], v[38:41], v[28:31]
    v_and_b32_dpp v42, v22, v4 quad_perm:[0,1,2,3] row_mask:0xf bank_mask:0x2
    v_and_b32_dpp v43, v22, v4 row_ror:8 row_mask:0xf bank_mask:0x8
    v_mfma_f32_16x16x32_bf16 v[32:35], v[88:91], v[36:39], v[32:35]
    s_waitcnt vmcnt(3)
    s_bitcmp1_b64 s[16:17], 53
    s_cbranch_scc1 L_t53
    s_waitcnt vmcnt(2)
L_t53:
    buffer_load_dwordx4 v[176:179], v3, s[32:35], s39 offen offset:1024 nt
    v_and_b32_dpp v38, v22, v4 row_ror:8 row_mask:0xf bank_mask:0x1
    v_and_b32_dpp v39, v22, v4 quad_perm:[0,1,2,3] row_mask:0xf bank_mask:0x4
    v_mfma_f32_16x16x32_bf16 v[28:31], v[92:95], v[42:45], v[28:31]
    v_and_b32_dpp v38, v22, v4 row_ror:12 row_mask:0xf bank_mask:0x2
    v_and_b32_dpp v39, v22, v4 row_ror:4 row_mask:0xf bank_mask:0x8
    v_mfma_f32_16x16x32_bf16 v[32:35], v[92:95], v[40:43], v[32:35]
    v_and_b32_dpp v42, v22, v4 row_ror:4 row_mask:0xf bank_mask:0x1
    v_and_b32_dpp v43, v22, v4 row_ror:12 row_mask:0xf bank_mask:0x4
    v_mfma_f32_16x16x32_bf16 v[28:31], v[96:99], v[38:41], v[28:31]
    v_and_b32_dpp v42, v22, v4 row_ror:8 row_mask:0xf bank_mask:0x2
    v_and_b32_dpp v43, v22, v4 quad_perm:[0,1,2,3] row_mask:0xf bank_mask:0x8
    v_mfma_f32_16x16x32_bf16 v[32:35], v[96:99], v[36:39], v[32:35]
    v_and_b32_dpp v38, v23, v4 quad_perm:[0,1,2,3] row_mask:0xf bank_mask:0x1
    v_and_b32_dpp v39, v23, v4 row_ror:8 row_mask:0xf bank_mask:0x4
    v_mfma_f32_16x16x32_bf16 v[28:31], v[100:103], v[42:45], v[28:31]
    v_and_b32_dpp v38, v23, v4 row_ror:4 row_mask:0xf bank_mask:0x2
    v_and_b32_dpp v39, v23, v4 row_ror:12 row_mask:0xf bank_mask:0x8
    v_mfma_f32_16x16x32_bf16 v[32:35], v[100:103], v[40:43], v[32:35]
    s_waitcnt vmcnt(3)
    s_bitcmp1_b64 s[16:17], 54
    s_cbranch_scc1 L_t54
    s_waitcnt vmcnt(2)
L_t54:
    buffer_load_dwordx4 v[192:195], v3, s[32:35], s39 offen offset:2048 nt
    v_and_b32_dpp v42, v23, v4 row_ror:12 row_mask:0xf bank_mask:0x1
    v_and_b32_dpp v43, v23, v4 row_ror:4 row_mask:0xf bank_mask:0x4
    v_mfma_f32_16x16x32_bf16 v[28:31], v[104:107], v[38:41], v[28:31]
    v_and_b32_dpp v42, v23, v4 quad_perm:[0,1,2,3] row_mask:0xf bank_mask:0x2
    v_and_b32_dpp v43, v23, v4 row_ror:8 row_mask:0xf bank_mask:0x8
    v_mfma_f32_16x16x32_bf16 v[32:35], v[104:107], v[36:39], v[32:35]
    v_and_b32_dpp v38, v23, v4 row_ror:8 row_mask:0xf bank_mask:0x1
    v_and_b32_dpp v39, v23, v4 quad_perm:[0,1,2,3] row_mask:0xf bank_mask:0x4
    v_mfma_f32_16x16x32_bf16 v[28:31], v[108:111], v[42:45], v[28:31]
    v_and_b32_dpp v38, v23, v4 row_ror:12 row_mask:0xf bank_mask:0x2
    v_and_b32_dpp v39, v23, v4 row_ror:4 row_mask:0xf bank_mask:0x8
    v_mfma_f32_16x16x32_bf16 v[32:35], v[108:111], v[40:43], v[32:35]
    v_and_b32_dpp v42, v23, v4 row_ror:4 row_mask:0xf bank_mask:0x1
    v_and_b32_dpp v43, v23, v4 row_ror:12 row_mask:0xf bank_mask:0x4
    v_mfma_f32_16x16x32_bf16 v[28:31], v[112:115], v[38:41], v[28:31]
    v_and_b32_dpp v42, v23, v4 row_ror:8 row_mask:0xf bank_mask:0x2
    v_and_b32_dpp v43, v23, v4 quad_perm:[0,1,2,3] row_mask:0xf bank_mask:0x8
    v_mfma_f32_16x16x32_bf16 v[32:35], v[112:115], v[36:39], v[32:35]
    s_waitcnt vmcnt(3)
    s_bitcmp1_b64 s[16:17], 55
    s_cbranch_scc1 L_t55
    s_waitcnt vmcnt(2)
L_t55:
    buffer_load_dwordx4 v[208:211], v3, s[32:35], s39 offen offset:3072 nt
    v_and_b32_dpp v38, v24, v4 quad_perm:[0,1,2,3] row_mask:0xf bank_mask:0x1
    v_and_b32_dpp v39, v24, v4 row_ror:8 row_mask:0xf bank_mask:0x4
    v_mfma_f32_16x16x32_bf16 v[28:31], v[116:119], v[42:45], v[28:31]
    v_and_b32_dpp v38, v24, v4 row_ror:4 row_mask:0xf bank_mask:0x2
    v_and_b32_dpp v39, v24, v4 row_ror:12 row_mask:0xf bank_mask:0x8
    v_mfma_f32_16x16x32_bf16 v[32:35], v[116:119], v[40:43], v[32:35]
    v_and_b32_dpp v42, v24, v4 row_ror:12 row_mask:0xf bank_mask:0x1
    v_and_b32_dpp v43, v24, v4 row_ror:4 row_mask:0xf bank_mask:0x4
    v_mfma_f32_16x16x32_bf16 v[28:31], v[120:123], v[38:41], v[28:31]
    v_and_b32_dpp v42, v24, v4 quad_perm:[0,1,2,3] row_mask:0xf bank_mask:0x2
    v_and_b32_dpp v43, v24, v4 row_ror:8 row_mask:0xf bank_mask:0x8
    v_mfma_f32_16x16x32_bf16 v[32:35], v[120:123], v[36:39], v[32:35]
    v_and_b32_dpp v38, v24, v4 row_ror:8 row_mask:0xf bank_mask:0x1
    v_and_b32_dpp v39, v24, v4 quad_perm:[0,1,2,3] row_mask:0xf bank_mask:0x4
    v_mfma_f32_16x16x32_bf16 v[28:31], v[124:127], v[42:45], v[28:31]
    v_and_b32_dpp v38, v24, v4 row_ror:12 row_mask:0xf bank_mask:0x2
    v_and_b32_dpp v39, v24, v4 row_ror:4 row_mask:0xf bank_mask:0x8
    v_mfma_f32_16x16x32_bf16 v[32:35], v[124:127], v[40:43], v[32:35]
    s_waitcnt vmcnt(3)
    s_bitcmp1_b64 s[16:17], 56
    s_cbranch_scc1 L_t56
    s_waitcnt vmcnt(2)
L_t56:
    s_add_u32 s39, s39, 32768
    buffer_load_dwordx4 v[224:227], v3, s[32:35], s39 offen offset:0 nt
    v_and_b32_dpp v42, v24, v4 row_ror:4 row_mask:0xf bank_mask:0x1
    v_and_b32_dpp v43, v24, v4 row_ror:12 row_mask:0xf bank_mask:0x4
    v_mfma_f32_16x16x32_bf16 v[28:31], v[128:131], v[38:41], v[28:31]
    v_and_b32_dpp v42, v24, v4 row_ror:8 row_mask:0xf bank_mask:0x2
    v_and_b32_dpp v43, v24, v4 quad_perm:[0,1,2,3] row_mask:0xf bank_mask:0x8
    v_mfma_f32_16x16x32_bf16 v[32:35], v[128:131], v[36:39], v[32:35]
    v_and_b32_dpp v38, v25, v4 quad_perm:[0,1,2,3] row_mask:0xf bank_mask:0x1
    v_and_b32_dpp v39, v25, v4 row_ror:8 row_mask:0xf bank_mask:0x4
    v_mfma_f32_16x16x32_bf16 v[28:31], v[144:147], v[42:45], v[28:31]
    v_and_b32_dpp v38, v25, v4 row_ror:4 row_mask:0xf bank_mask:0x2
    v_and_b32_dpp v39, v25, v4 row_ror:12 row_mask:0xf bank_mask:0x8
    v_mfma_f32_16x16x32_bf16 v[32:35], v[144:147], v[40:43], v[32:35]
    v_and_b32_dpp v42, v25, v4 row_ror:12 row_mask:0xf bank_mask:0x1
    v_and_b32_dpp v43, v25, v4 row_ror:4 row_mask:0xf bank_mask:0x4
    v_mfma_f32_16x16x32_bf16 v[28:31], v[160:163], v[38:41], v[28:31]
    v_and_b32_dpp v42, v25, v4 quad_perm:[0,1,2,3] row_mask:0xf bank_mask:0x2
    v_and_b32_dpp v43, v25, v4 row_ror:8 row_mask:0xf bank_mask:0x8
    v_mfma_f32_16x16x32_bf16 v[32:35], v[160:163], v[36:39], v[32:35]
    s_waitcnt vmcnt(3)
    s_bitcmp1_b64 s[16:17], 57
    s_cbranch_scc1 L_t57
    s_waitcnt vmcnt(2)
L_t57:
    buffer_load_dwordx4 v[240:243], v3, s[32:35], s39 offen offset:1024 nt
    v_and_b32_dpp v38, v25, v4 row_ror:8 row_mask:0xf bank_mask:0x1
    v_and_b32_dpp v39, v25, v4 quad_perm:[0,1,2,3] row_mask:0xf bank_mask:0x4
    v_mfma_f32_16x16x32_bf16 v[28:31], v[176:179], v[42:45], v[28:31]
    v_and_b32_dpp v38, v25, v4 row_ror:12 row_mask:0xf bank_mask:0x2
    v_and_b32_dpp v39, v25, v4 row_ror:4 row_mask:0xf bank_mask:0x8
    v_mfma_f32_16x16x32_bf16 v[32:35], v[176:179], v[40:43], v[32:35]
    s_waitcnt vmcnt(3)
    s_bitcmp1_b64 s[16:17], 58
    s_cbranch_scc1 L_t58
    s_waitcnt vmcnt(2)
L_t58:
    buffer_load_dwordx4 v[132:135], v3, s[32:35], s39 offen offset:2048 nt
    global_load_dwordx4 v[152:155], v49, s[26:27]
    global_load_dword v236, v48, s[26:27]
    global_load_ushort v237, v52, s[4:5]
    v_and_b32_dpp v42, v25, v4 row_ror:4 row_mask:0xf bank_mask:0x1
    v_and_b32_dpp v43, v25, v4 row_ror:12 row_mask:0xf bank_mask:0x4
    v_mfma_f32_16x16x32_bf16 v[28:31], v[192:195], v[38:41], v[28:31]
    v_and_b32_dpp v42, v25, v4 row_ror:8 row_mask:0xf bank_mask:0x2
    v_and_b32_dpp v43, v25, v4 quad_perm:[0,1,2,3] row_mask:0xf bank_mask:0x8
    v_mfma_f32_16x16x32_bf16 v[32:35], v[192:195], v[36:39], v[32:35]
    s_waitcnt vmcnt(6)
    s_bitcmp1_b64 s[16:17], 59
    s_cbranch_scc1 L_t59
    s_waitcnt vmcnt(5)
L_t59:
    buffer_load_dwordx4 v[148:151], v3, s[32:35], s39 offen offset:3072 nt
    v_and_b32_dpp v38, v26, v4 quad_perm:[0,1,2,3] row_mask:0xf bank_mask:0x1
    v_and_b32_dpp v39, v26, v4 row_ror:8 row_mask:0xf bank_mask:0x4
    v_mfma_f32_16x16x32_bf16 v[28:31], v[208:211], v[42:45], v[28:31]
    v_and_b32_dpp v38, v26, v4 row_ror:4 row_mask:0xf bank_mask:0x2
    v_and_b32_dpp v39, v26, v4 row_ror:12 row_mask:0xf bank_mask:0x8
    v_mfma_f32_16x16x32_bf16 v[32:35], v[208:211], v[40:43], v[32:35]
    s_waitcnt vmcnt(6)
    s_bitcmp1_b64 s[16:17], 60
    s_cbranch_scc1 L_t60
    s_waitcnt vmcnt(5)
L_t60:
    s_add_u32 s39, s39, 32768
    buffer_load_dwordx4 v[164:167], v3, s[32:35], s39 offen offset:0 nt
    v_and_b32_dpp v42, v26, v4 row_ror:12 row_mask:0xf bank_mask:0x1
    v_and_b32_dpp v43, v26, v4 row_ror:4 row_mask:0xf bank_mask:0x4
    v_mfma_f32_16x16x32_bf16 v[28:31], v[224:227], v[38:41], v[28:31]
    v_and_b32_dpp v42, v26, v4 quad_perm:[0,1,2,3] row_mask:0xf bank_mask:0x2
    v_and_b32_dpp v43, v26, v4 row_ror:8 row_mask:0xf bank_mask:0x8
    v_mfma_f32_16x16x32_bf16 v[32:35], v[224:227], v[36:39], v[32:35]
    s_waitcnt vmcnt(6)
    s_bitcmp1_b64 s[16:17], 61
    s_cbranch_scc1 L_t61
    s_waitcnt vmcnt(5)
L_t61:
    buffer_load_dwordx4 v[180:183], v3, s[32:35], s39 offen offset:1024 nt
    v_and_b32_dpp v38, v26, v4 row_ror:8 row_mask:0xf bank_mask:0x1
    v_and_b32_dpp v39, v26, v4 quad_perm:[0,1,2,3] row_mask:0xf bank_mask:0x4
    v_mfma_f32_16x16x32_bf16 v[28:31], v[240:243], v[42:45], v[28:31]
    v_and_b32_dpp v38, v26, v4 row_ror:12 row_mask:0xf bank_mask:0x2
    v_and_b32_dpp v39, v26, v4 row_ror:4 row_mask:0xf bank_mask:0x8
    v_mfma_f32_16x16x32_bf16 v[32:35], v[240:243], v[40:43], v[32:35]
    s_waitcnt vmcnt(6)
    s_bitcmp1_b64 s[16:17], 62
    s_cbranch_scc1 L_t62
    s_waitcnt vmcnt(2)
L_t62:
    buffer_load_dwordx4 v[196:199], v3, s[32:35], s39 offen offset:2048 nt
    v_and_b32_dpp v42, v26, v4 row_ror:4 row_mask:0xf bank_mask:0x1
    v_and_b32_dpp v43, v26, v4 row_ror:12 row_mask:0xf bank_mask:0x4
    v_mfma_f32_16x16x32_bf16 v[28:31], v[132:135], v[38:41], v[28:31]
    v_and_b32_dpp v42, v26, v4 row_ror:8 row_mask:0xf bank_mask:0x2
    v_and_b32_dpp v43, v26, v4 quad_perm:[0,1,2,3] row_mask:0xf bank_mask:0x8
    v_mfma_f32_16x16x32_bf16 v[32:35], v[132:135], v[36:39], v[32:35]
    s_waitcnt vmcnt(3)
    s_bitcmp1_b64 s[16:17], 63
    s_cbranch_scc1 L_t63
    s_waitcnt vmcnt(2)
L_t63:
    buffer_load_dwordx4 v[212:215], v3, s[32:35], s39 offen offset:3072 nt
    s_mov_b32 s48, 0
L_hchk:
    v_bitop3_b32 v54, v236, v236, s15 bitop3:0x7e
    v_bitop3_b32 v54, v54, v54, s100 bitop3:0xa8
    v_cmp_ne_u32 vcc, 0, v54
    s_cbranch_vccz L_hok
    s_add_u32 s48, s48, 1
    s_cmp_gt_u32 s48, 131072
    s_cbranch_scc1 L_hok
    s_sleep 2
    global_load_dword v236, v48, s[26:27] sc1
    s_waitcnt vmcnt(0)
    s_branch L_hchk
L_hok:
    v_add_f32_dpp v236, v236, v236 quad_perm:[1,0,3,2] row_mask:0xf bank_mask:0xf
    v_bitop3_b32 v54, v152, v153, s15 bitop3:0x7e
    v_bitop3_b32 v55, v155, v155, s15 bitop3:0x7e
    v_bitop3_b32 v54, v54, v55, s100 bitop3:0xa8
    v_bitop3_b32 v55, v154, v154, s14 bitop3:0x7e
    v_or_b32 v54, v54, v55
    v_cmp_ne_u32 vcc, 0, v54
    v_add_f32_dpp v236, v236, v236 quad_perm:[2,3,0,1] row_mask:0xf bank_mask:0xf
    s_cmp_lg_u64 vcc, 0
    s_cselect_b32 s101, 0, 1
    v_cmp_ne_u32 vcc, s52, v155
    s_cmp_lg_u64 vcc, 0
    s_cselect_b32 s52, 0, s101
    v_mov_b32 v188, v236
    v_mov_b32 v189, v236
    s_nop 0
    v_mov_b32_dpp v188, v236 row_ror:4 row_mask:0xf bank_mask:0xa
    v_mov_b32_dpp v189, v236 row_ror:4 row_mask:0xf bank_mask:0x5
    v_cvt_pk_bf16_f32 v190, v188, v188
    v_lshlrev_b32 v188, 16, v190
    v_cvt_pk_bf16_f32 v191, v189, v189
    v_lshlrev_b32 v189, 16, v191
    v_mul_f32 v190, v188, v188
    v_mov_b32 v191, 0xc0135761
    v_fmac_f32 v191, 0xbdd2d3e8, v190
    v_mul_f32 v191, v191, v188
    v_exp_f32 v191, v191
    s_nop 0
    v_add_f32 v191, 1.0, v191
    v_rcp_f32 v191, v191
    s_nop 0
    v_mul_f32 v188, v188, v191
    v_cvt_pk_bf16_f32 v190, v188, v188
    v_lshlrev_b32 v188, 16, v190
    v_mul_f32 v188, v188, v189
    v_cvt_pk_bf16_f32 v188, v188, v188
    s_cmp_lt_u32 s3, 7
    s_cselect_b32 s40, -1, 0
    v_and_b32 v188, s40, v188
    v_and_b32 v184, v188, v10
    v_and_b32 v185, v188, v11
    v_and_b32 v186, v188, v12
    v_and_b32 v187, v188, v13
    v_and_b32 v152, s49, v152
    v_mov_b32 v248, v152
    s_nop 1
    v_max_f32_dpp v248, v248, v248 row_ror:4 row_mask:0xf bank_mask:0xf
    s_nop 1
    v_max_f32_dpp v248, v248, v248 row_ror:2 row_mask:0xf bank_mask:0xf
    s_nop 1
    v_max_f32_dpp v248, v248, v248 row_ror:1 row_mask:0xf bank_mask:0xf
    v_mov_b32 v249, v248
    s_nop 1
    v_permlane16_swap_b32 v249, v248
    v_max_f32 v248, v249, v248
    v_mov_b32 v249, v248
    s_nop 1
    v_permlane32_swap_b32 v249, v248
    v_max_f32 v248, v249, v248
    v_sub_f32 v248, v152, v248
    v_mul_f32 v248, s45, v248
    v_exp_f32 v248, v248
    s_nop 0
    v_mul_f32 v250, v248, v153
    s_nop 1
    v_add_f32_dpp v250, v250, v250 row_ror:4 row_mask:0xf bank_mask:0xf
    s_nop 1
    v_add_f32_dpp v250, v250, v250 row_ror:2 row_mask:0xf bank_mask:0xf
    s_nop 1
    v_add_f32_dpp v250, v250, v250 row_ror:1 row_mask:0xf bank_mask:0xf
    v_mov_b32 v249, v250
    s_nop 1
    v_permlane16_swap_b32 v249, v250
    v_add_f32 v250, v249, v250
    v_mov_b32 v249, v250
    s_nop 1
    v_permlane32_swap_b32 v249, v250
    v_add_f32 v250, v249, v250
    v_rcp_f32 v250, v250
    s_nop 1
    v_mul_f32_dpp v251, v248, v250 row_newbcast:0 row_mask:0xf bank_mask:0xf
    v_and_b32_dpp v38, v27, v4 quad_perm:[0,1,2,3] row_mask:0xf bank_mask:0x1
    v_and_b32_dpp v39, v27, v4 row_ror:8 row_mask:0xf bank_mask:0x4
    v_mfma_f32_16x16x32_bf16 v[28:31], v[148:151], v[42:45], v[28:31]
    v_and_b32_dpp v38, v27, v4 row_ror:4 row_mask:0xf bank_mask:0x2
    v_and_b32_dpp v39, v27, v4 row_ror:12 row_mask:0xf bank_mask:0x8
    v_mfma_f32_16x16x32_bf16 v[32:35], v[148:151], v[40:43], v[32:35]
    s_waitcnt vmcnt(3)
    v_and_b32_dpp v42, v27, v4 row_ror:12 row_mask:0xf bank_mask:0x1
    v_and_b32_dpp v43, v27, v4 row_ror:4 row_mask:0xf bank_mask:0x4
    v_mfma_f32_16x16x32_bf16 v[28:31], v[164:167], v[38:41], v[28:31]
    v_and_b32_dpp v42, v27, v4 quad_perm:[0,1,2,3] row_mask:0xf bank_mask:0x2
    v_and_b32_dpp v43, v27, v4 row_ror:8 row_mask:0xf bank_mask:0x8
    v_mfma_f32_16x16x32_bf16 v[32:35], v[164:167], v[36:39], v[32:35]
    s_waitcnt vmcnt(2)
    v_and_b32_dpp v38, v27, v4 row_ror:8 row_mask:0xf bank_mask:0x1
    v_and_b32_dpp v39, v27, v4 quad_perm:[0,1,2,3] row_mask:0xf bank_mask:0x4
    v_mfma_f32_16x16x32_bf16 v[28:31], v[180:183], v[42:45], v[28:31]
    v_and_b32_dpp v38, v27, v4 row_ror:12 row_mask:0xf bank_mask:0x2
    v_and_b32_dpp v39, v27, v4 row_ror:4 row_mask:0xf bank_mask:0x8
    v_mfma_f32_16x16x32_bf16 v[32:35], v[180:183], v[40:43], v[32:35]
    s_waitcnt vmcnt(1)
    global_load_dwordx4 v[136:139], v47, s[20:21] nt
    global_load_dwordx4 v[228:231], v46, s[12:13] nt
    global_load_dwordx4 v[244:247], v46, s[12:13] offset:1024 nt
    v_and_b32_dpp v42, v27, v4 row_ror:4 row_mask:0xf bank_mask:0x1
    v_and_b32_dpp v43, v27, v4 row_ror:12 row_mask:0xf bank_mask:0x4
    v_mfma_f32_16x16x32_bf16 v[28:31], v[196:199], v[38:41], v[28:31]
    v_and_b32_dpp v42, v27, v4 row_ror:8 row_mask:0xf bank_mask:0x2
    v_and_b32_dpp v43, v27, v4 quad_perm:[0,1,2,3] row_mask:0xf bank_mask:0x8
    v_mfma_f32_16x16x32_bf16 v[32:35], v[196:199], v[36:39], v[32:35]
    s_waitcnt vmcnt(3)
    v_mfma_f32_16x16x32_bf16 v[28:31], v[212:215], v[42:45], v[28:31]
    v_mfma_f32_16x16x32_bf16 v[32:35], v[212:215], v[40:43], v[32:35]
    s_lshr_b32 s40, s3, 1
    s_lshl_b32 s40, s40, 5
    v_mov_b32 v55, s40
    s_nop 3
    ds_write_b128 v51, v[28:31] offset:2048
    ds_write_b128 v51, v[32:35] offset:2304
    s_waitcnt lgkmcnt(0)
    s_barrier
    ds_read_b64 v[140:141], v238 offset:256
    ds_read_b128 v[56:59], v255 offset:2048
    ds_read_b128 v[60:63], v255 offset:4096
    s_mov_b32 s48, 0
    s_cmp_lg_u32 s52, 0
    s_waitcnt lgkmcnt(1)
    v_mul_f32 v56, v56, v140
    v_mul_f32 v57, v57, v140
    v_mul_f32 v58, v58, v140
    v_mul_f32 v59, v59, v140
    s_waitcnt lgkmcnt(0)
    v_fmac_f32 v56, v60, v141
    v_fmac_f32 v58, v62, v141
    v_fmac_f32 v57, v61, v141
    v_fmac_f32 v59, v63, v141
    v_permlane32_swap_b32 v56, v58
    s_nop 0
    v_permlane32_swap_b32 v57, v59
    v_add_f32 v56, v56, v58
    v_add_f32 v57, v57, v59
    s_nop 1
    v_permlane16_swap_b32 v56, v57
    v_add_f32 v56, v56, v57
    v_and_or_b32 v56, v56, s49, v0
    s_cbranch_scc0 L_p3far
    global_store_dword v14, v56, s[26:27]
    s_branch L_p3chk
L_p3far:
    global_store_dword v14, v56, s[26:27] sc1
    s_mov_b32 s48, 0
    s_cmp_lg_u32 s101, 0
    s_cbranch_scc1 L_p3chk
L_mlchk:
    global_load_dwordx4 v[152:155], v49, s[26:27] sc1
    s_waitcnt vmcnt(0)
    v_bitop3_b32 v54, v152, v153, s15 bitop3:0x7e
    v_bitop3_b32 v55, v155, v155, s15 bitop3:0x7e
    v_bitop3_b32 v54, v54, v55, s100 bitop3:0xa8
    v_bitop3_b32 v55, v154, v154, s14 bitop3:0x7e
    v_or_b32 v54, v54, v55
    v_cmp_ne_u32 vcc, 0, v54
    s_cbranch_vccz L_mlok
    s_add_u32 s48, s48, 1
    s_cmp_gt_u32 s48, 131072
    s_cbranch_scc1 L_mlok
    s_sleep 4
    s_branch L_mlchk
L_mlok:
    v_and_b32 v152, s49, v152
    v_mov_b32 v248, v152
    s_nop 1
    v_max_f32_dpp v248, v248, v248 row_ror:4 row_mask:0xf bank_mask:0xf
    s_nop 1
    v_max_f32_dpp v248, v248, v248 row_ror:2 row_mask:0xf bank_mask:0xf
    s_nop 1
    v_max_f32_dpp v248, v248, v248 row_ror:1 row_mask:0xf bank_mask:0xf
    v_mov_b32 v249, v248
    s_nop 1
    v_permlane16_swap_b32 v249, v248
    v_max_f32 v248, v249, v248
    v_mov_b32 v249, v248
    s_nop 1
    v_permlane32_swap_b32 v249, v248
    v_max_f32 v248, v249, v248
    v_sub_f32 v248, v152, v248
    v_mul_f32 v248, s45, v248
    v_exp_f32 v248, v248
    s_nop 0
    v_mul_f32 v250, v248, v153
    s_nop 1
    v_add_f32_dpp v250, v250, v250 row_ror:4 row_mask:0xf bank_mask:0xf
    s_nop 1
    v_add_f32_dpp v250, v250, v250 row_ror:2 row_mask:0xf bank_mask:0xf
    s_nop 1
    v_add_f32_dpp v250, v250, v250 row_ror:1 row_mask:0xf bank_mask:0xf
    v_mov_b32 v249, v250
    s_nop 1
    v_permlane16_swap_b32 v249, v250
    v_add_f32 v250, v249, v250
    v_mov_b32 v249, v250
    s_nop 1
    v_permlane32_swap_b32 v249, v250
    v_add_f32 v250, v249, v250
    v_rcp_f32 v250, v250
    s_nop 1
    v_mul_f32_dpp v251, v248, v250 row_newbcast:0 row_mask:0xf bank_mask:0xf
    s_mov_b32 s48, 0
L_p3chk:
    global_load_dwordx4 v[168:171], v50, s[26:27] sc1
    s_waitcnt vmcnt(0)
    v_bitop3_b32 v54, v168, v169, s15 bitop3:0x7e
    v_bitop3_b32 v55, v170, v171, s15 bitop3:0x7e
    v_bitop3_b32 v54, v54, v55, s100 bitop3:0xa8
    v_cmp_ne_u32 vcc, 0, v54
    s_cbranch_vccz L_p3ok
    s_add_u32 s48, s48, 1
    s_cmp_gt_u32 s48, 131072
    s_cbranch_scc1 L_p3ok
    s_branch L_p3chk
L_p3ok:
    v_mul_f32 v168, v168, v251
    v_mul_f32 v169, v169, v251
    v_mul_f32 v170, v170, v251
    v_mul_f32 v171, v171, v251
    v_mfma_f32_16x16x32_bf16 v[200:203], v[136:139], v[184:187], 0
    v_permlane32_swap_b32 v168, v170
    v_permlane32_swap_b32 v169, v171
    v_add_f32 v168, v168, v170
    v_add_f32 v169, v169, v171
    s_nop 1
    v_permlane16_swap_b32 v168, v169
    v_add_f32 v168, v168, v169
    ds_write_b32 v252, v168 offset:26624
    s_lshl_b32 s40, s3, 10
    v_add_u32 v54, s40, v3
    s_waitcnt lgkmcnt(0)
    s_barrier
    ds_read_b32 v168, v253 offset:26624
    s_waitcnt lgkmcnt(0)
    v_add_f32_dpp v168, v168, v168 quad_perm:[1,0,3,2] row_mask:0xf bank_mask:0xf
    s_nop 1
    v_add_f32_dpp v168, v168, v168 quad_perm:[2,3,0,1] row_mask:0xf bank_mask:0xf
    s_nop 1
    v_add_f32_dpp v168, v168, v168 row_half_mirror row_mask:0xf bank_mask:0xf
    v_cvt_pk_bf16_f32 v168, v168, v168
    v_and_b32 v216, v168, v6
    v_and_b32 v217, v168, v7
    v_and_b32 v218, v168, v8
    v_and_b32 v219, v168, v9
    v_and_b32_dpp v232, v168, v6 row_ror:8 row_mask:0xf bank_mask:0xf
    v_and_b32_dpp v233, v168, v7 row_ror:8 row_mask:0xf bank_mask:0xf
    v_and_b32_dpp v234, v168, v8 row_ror:8 row_mask:0xf bank_mask:0xf
    v_and_b32_dpp v235, v168, v9 row_ror:8 row_mask:0xf bank_mask:0xf
    v_mfma_f32_16x16x32_bf16 v[200:203], v[228:231], v[216:219], v[200:203]
    s_nop 0
    v_mfma_f32_16x16x32_bf16 v[200:203], v[244:247], v[232:235], v[200:203]
    s_nop 7
    ds_write_b128 v54, v[200:203] offset:18432
    s_waitcnt lgkmcnt(0)
    s_barrier
    ds_read_b128 v[56:59], v239 offset:18432
    s_waitcnt lgkmcnt(0)
    v_permlane32_swap_b32 v56, v58
    v_permlane32_swap_b32 v57, v59
    v_add_f32 v56, v56, v58
    v_add_f32 v57, v57, v59
    s_nop 1
    v_permlane16_swap_b32 v56, v57
    v_add_f32 v56, v56, v57
    s_nop 1
    v_add_f32_dpp v56, v56, v56 row_ror:8 row_mask:0xf bank_mask:0xf
    v_and_or_b32 v56, v56, s49, v0
    s_mov_b32 exec_lo, 0x00ff00ff
    s_mov_b32 exec_hi, 0x00ff00ff
    global_store_dword v15, v56, s[26:27] sc1
    s_mov_b64 exec, -1
L_nop4:
    s_cmp_ge_u32 s2, 16
    s_cbranch_scc1 L_end2
    s_lshl_b32 s40, s2, 14
    s_add_u32 s40, s40, 0x80000
    v_add_u32 v46, s40, v54
    v_add_u32 v47, 0x2000, v46
    s_mov_b32 s48, 0
    global_load_dwordx4 v[96:99], v46, s[26:27] sc1
    global_load_dwordx4 v[100:103], v47, s[26:27] sc1
    s_sleep 6
    global_load_dwordx4 v[104:107], v46, s[26:27] sc1
    global_load_dwordx4 v[108:111], v47, s[26:27] sc1
    s_sleep 6
    global_load_dwordx4 v[112:115], v46, s[26:27] sc1
    global_load_dwordx4 v[116:119], v47, s[26:27] sc1
L_p4loop:
    s_waitcnt vmcnt(4)
    v_bitop3_b32 v54, v96, v97, s15 bitop3:0x7e
    v_bitop3_b32 v55, v98, v99, s15 bitop3:0x7e
    v_or_b32 v54, v54, v55
    v_bitop3_b32 v55, v100, v101, s15 bitop3:0x7e
    v_or_b32 v54, v54, v55
    v_bitop3_b32 v55, v102, v103, s15 bitop3:0x7e
    v_bitop3_b32 v54, v54, v55, s100 bitop3:0xa8
    v_cmp_ne_u32 vcc, 0, v54
    s_cbranch_vccz L_p4ok0
    global_load_dwordx4 v[96:99], v46, s[26:27] sc1
    global_load_dwordx4 v[100:103], v47, s[26:27] sc1
    s_waitcnt vmcnt(4)
    v_bitop3_b32 v54, v104, v105, s15 bitop3:0x7e
    v_bitop3_b32 v55, v106, v107, s15 bitop3:0x7e
    v_or_b32 v54, v54, v55
    v_bitop3_b32 v55, v108, v109, s15 bitop3:0x7e
    v_or_b32 v54, v54, v55
    v_bitop3_b32 v55, v110, v111, s15 bitop3:0x7e
    v_bitop3_b32 v54, v54, v55, s100 bitop3:0xa8
    v_cmp_ne_u32 vcc, 0, v54
    s_cbranch_vccz L_p4ok1
    global_load_dwordx4 v[104:107], v46, s[26:27] sc1
    global_load_dwordx4 v[108:111], v47, s[26:27] sc1
    s_waitcnt vmcnt(4)
    v_bitop3_b32 v54, v112, v113, s15 bitop3:0x7e
    v_bitop3_b32 v55, v114, v115, s15 bitop3:0x7e
    v_or_b32 v54, v54, v55
    v_bitop3_b32 v55, v116, v117, s15 bitop3:0x7e
    v_or_b32 v54, v54, v55
    v_bitop3_b32 v55, v118, v119, s15 bitop3:0x7e
    v_bitop3_b32 v54, v54, v55, s100 bitop3:0xa8
    v_cmp_ne_u32 vcc, 0, v54
    s_cbranch_vccz L_p4ok2
    global_load_dwordx4 v[112:115], v46, s[26:27] sc1
    global_load_dwordx4 v[116:119], v47, s[26:27] sc1
    s_add_u32 s48, s48, 1
    s_cmp_gt_u32 s48, 131072
    s_cbranch_scc0 L_p4loop
    s_waitcnt vmcnt(0)
L_p4ok0:
    s_nop 1
    v_permlane32_swap_b32 v96, v98
    v_permlane32_swap_b32 v97, v99
    v_permlane32_swap_b32 v100, v102
    v_permlane32_swap_b32 v101, v103
    v_add_f32 v168, v96, v98
    v_add_f32 v169, v97, v99
    v_add_f32 v184, v100, v102
    v_add_f32 v185, v101, v103
    s_branch L_p4ok
L_p4ok1:
    s_nop 1
    v_permlane32_swap_b32 v104, v106
    v_permlane32_swap_b32 v105, v107
    v_permlane32_swap_b32 v108, v110
    v_permlane32_swap_b32 v109, v111
    v_add_f32 v168, v104, v106
    v_add_f32 v169, v105, v107
    v_add_f32 v184, v108, v110
    v_add_f32 v185, v109, v111
    s_branch L_p4ok
L_p4ok2:
    s_nop 1
    v_permlane32_swap_b32 v112, v114
    v_permlane32_swap_b32 v113, v115
    v_permlane32_swap_b32 v116, v118
    v_permlane32_swap_b32 v117, v119
    v_add_f32 v168, v112, v114
    v_add_f32 v169, v113, v115
    v_add_f32 v184, v116, v118
    v_add_f32 v185, v117, v119
L_p4ok:
    s_nop 1
    v_permlane16_swap_b32 v168, v169
    v_permlane16_swap_b32 v184, v185
    v_add_f32 v168, v168, v169
    v_add_f32 v184, v184, v185
    s_nop 0
    v_add_f32_dpp v168, v168, v168 row_ror:8 row_mask:0xf bank_mask:0x3
    s_nop 1
    v_add_f32_dpp v168, v184, v184 row_ror:8 row_mask:0xf bank_mask:0xc
    ds_write_b32 v254, v168 offset:28928
    v_lshlrev_b32 v54, 2, v1
    s_waitcnt lgkmcnt(0)
    s_barrier
    s_cmp_lg_u32 s3, 0
    s_cbranch_scc1 L_end2
    ds_read2st64_b32 v[56:57], v54 offset0:113 offset1:114
    ds_read2st64_b32 v[58:59], v54 offset0:115 offset1:116
    ds_read2st64_b32 v[60:61], v54 offset0:117 offset1:118
    ds_read2st64_b32 v[62:63], v54 offset0:119 offset1:120
    v_lshlrev_b32 v237, 16, v237
    s_waitcnt lgkmcnt(0)
    v_add_f32 v56, v56, v57
    v_add_f32 v58, v58, v59
    v_add_f32 v60, v60, v61
    v_add_f32 v62, v62, v63
    v_add_f32 v56, v56, v58
    v_add_f32 v60, v60, v62
    v_add_f32 v168, v56, v60
    v_cvt_pk_bf16_f32 v169, v168, v168
    v_lshlrev_b32 v168, 16, v169
    v_mul_f32 v186, s45, v168
    v_exp_f32 v186, -v186
    s_nop 0
    v_add_f32 v186, 1.0, v186
    v_rcp_f32 v186, v186
    s_nop 0
    v_mul_f32 v184, v168, v186
    v_cvt_pk_bf16_f32 v185, v184, v184
    v_lshlrev_b32 v184, 16, v185
    s_nop 1
    v_mul_f32_dpp v168, v184, v168 row_ror:8 row_mask:0xf bank_mask:0xf
    v_cvt_pk_bf16_f32 v169, v168, v168
    v_lshlrev_b32 v168, 16, v169
    v_add_f32 v168, v168, v237
    v_cvt_pk_bf16_f32 v168, v168, v168
    s_mov_b32 exec_lo, 0x00ff00ff
    s_mov_b32 exec_hi, 0x00ff00ff
    global_store_short v52, v168, s[22:23]
    s_cmp_lg_u32 s2, 0
    s_cbranch_scc1 L_end2
    s_mov_b64 exec, 1
    v_mov_b32 v54, 0x40000
    v_mov_b32 v55, s14
    global_store_dword v54, v55, s[26:27] sc1
L_end2:
L_end:
s_endpgm
.section .rodata,"a"
.p2align 6
.amdhsa_kernel recurrent_scan__gqa_block_cached__glu_gated_geglu__decode_kernel
  .amdhsa_next_free_vgpr 256
  .amdhsa_next_free_sgpr 102
  .amdhsa_accum_offset 256
  .amdhsa_group_segment_fixed_size 0
  .amdhsa_kernarg_size 96
  .amdhsa_user_sgpr_count 2
  .amdhsa_user_sgpr_kernarg_segment_ptr 1
  .amdhsa_system_sgpr_workgroup_id_x 1
.end_amdhsa_kernel
```
